```python
import torch

def _softmax(x, axis=-1):
    return torch.softmax(x, dim=axis)
def _gelu(x):
    return torch.nn.functional.gelu(x, approximate="tanh")
def _silu(x):
    return torch.nn.functional.silu(x)
def _sigmoid(x):
    return torch.sigmoid(x)
def _layernorm(x, axis=-1, eps=1e-5):
    m = x.mean(dim=axis, keepdim=True)
    v = x.var(dim=axis, keepdim=True, unbiased=False)
    return (x - m) / torch.sqrt(v + eps)
def _scatter_add(tgt, idx, src, axis=0):
    return tgt.clone().index_add_(axis, idx, src)
def _segment_sum(src, seg, n):
    out = torch.zeros((n,) + src.shape[1:], dtype=src.dtype)
    return out.index_add_(0, seg, src)
def _pad(x, pw):
    flat = tuple(v for pair in reversed(pw) for v in pair)
    return torch.nn.functional.pad(x, flat)

kernel_name = 'parallel_sum__ssm_conv_s5__glu_gated_geglu__prompt'

def setup_inputs():

    _w = (lambda a: (lambda t: t.to(torch.bfloat16) if t.is_floating_point() else t)(torch.as_tensor(a)))
    def _A_setup():
        B, S, D = 1, 2048, 512
        P = D
        Lambda_re = -0.5 * (lambda _x: torch.exp(torch.as_tensor(_x)))((lambda *s: torch.randn(*s, dtype=torch.bfloat16) * 0.2)(P))
        Lambda_im = (lambda *s: torch.randn(*s, dtype=torch.bfloat16) * 0.4)(P) * 1.0
        B_re = (lambda *s: torch.randn(*s, dtype=torch.bfloat16) * 0.2)(P, D) * (D ** -0.5)
        B_im = (lambda *s: torch.randn(*s, dtype=torch.bfloat16) * 0.2)(P, D) * (D ** -0.5)
        C_re = (lambda *s: torch.randn(*s, dtype=torch.bfloat16) * 0.2)(D, P) * (P ** -0.5)
        C_im = (lambda *s: torch.randn(*s, dtype=torch.bfloat16) * 0.2)(D, P) * (P ** -0.5)
        log_dt = (lambda *s: torch.randn(*s, dtype=torch.bfloat16) * 0.2)(P) * 0.3 - 2.0
        Dskip = (lambda *s: torch.randn(*s, dtype=torch.bfloat16) * 0.05)(D)
        return {
            "x": _w((lambda *s: torch.randn(*s, dtype=torch.bfloat16) * 0.05)(B, S, D)),
            "Lambda_re": _w(Lambda_re),
            "Lambda_im": _w(Lambda_im),
            "B_re": _w(B_re),
            "B_im": _w(B_im),
            "C_re": _w(C_re),
            "C_im": _w(C_im),
            "log_dt": _w(log_dt),
            "Dskip": _w(Dskip),
        }
    _A_in = _A_setup()

    def _B_setup():
        B, S, Dm, Df = 1, 2048, 512, 1376
        return {
            "x": _w((lambda *s: torch.randn(*s, dtype=torch.bfloat16) * 0.05)(B, S, Dm)),
            "w_gate": _w((lambda *s: torch.randn(*s, dtype=torch.bfloat16) * 0.4)(Dm, Df) * (Dm ** -0.5)),
            "w_up": _w((lambda *s: torch.randn(*s, dtype=torch.bfloat16) * 0.4)(Dm, Df) * (Dm ** -0.5)),
            "w_down": _w((lambda *s: torch.randn(*s, dtype=torch.bfloat16) * 0.4)(Df, Dm) * (Df ** -0.5)),
        }
    _B_in = _B_setup()

    return {
        "A_x": _A_in["x"],
        "A_Lambda_re": _A_in["Lambda_re"],
        "A_Lambda_im": _A_in["Lambda_im"],
        "A_B_re": _A_in["B_re"],
        "A_B_im": _A_in["B_im"],
        "A_C_re": _A_in["C_re"],
        "A_C_im": _A_in["C_im"],
        "A_log_dt": _A_in["log_dt"],
        "A_Dskip": _A_in["Dskip"],
        "B_x": _B_in["x"],
        "B_w_gate": _B_in["w_gate"],
        "B_w_up": _B_in["w_up"],
        "B_w_down": _B_in["w_down"],
    }

def reference(A_x, A_Lambda_re, A_Lambda_im, A_B_re, A_B_im, A_C_re, A_C_im, A_log_dt, A_Dskip, B_x, B_w_gate, B_w_up, B_w_down):
    def _A_ref(x, Lambda_re, Lambda_im, B_re, B_im, C_re, C_im, log_dt, Dskip):
        Bsz, L, H = x.shape
        Lam = Lambda_re + 1j * Lambda_im
        Bmat = B_re + 1j * B_im
        Cmat = C_re + 1j * C_im
        dt = torch.exp(log_dt)
        Lam_bar = torch.exp(dt * Lam)
        B_bar = ((Lam_bar - 1.0) / Lam)[:, None] * Bmat
        Bu = torch.einsum("bld,pd->blp", x + 0j, B_bar)
        h = torch.zeros_like(Bu[:, 0, :])
        hs = []
        for t in range(L):
            h = Lam_bar[None, :] * h + Bu[:, t, :]
            hs.append(h)
        hseq = torch.stack(hs, 1)
        y = 2.0 * torch.einsum("blp,dp->bld", hseq, Cmat).real + x * Dskip[None, None, :]
        return y

    def _B_ref(x, w_gate, w_up, w_down):
        g = torch.einsum("bsd,df->bsf", x, w_gate)
        u = torch.einsum("bsd,df->bsf", x, w_up)
        h = _gelu(g) * u
        return torch.einsum("bsf,fd->bsd", h, w_down)

    x = A_x
    xn = _layernorm(x, axis=-1)
    return x + _A_ref(xn, A_Lambda_re, A_Lambda_im, A_B_re, A_B_im, A_C_re, A_C_im, A_log_dt, A_Dskip) + _B_ref(xn, B_w_gate, B_w_up, B_w_down)
```

```asm
; @launch grid=(256,1,1) block=(512,1,1) lds=163840
.amdgcn_target "amdgcn-amd-amdhsa--gfx950"
.text
.globl parallel_sum__ssm_conv_s5__glu_gated_geglu__prompt_kernel
.p2align 8
.type parallel_sum__ssm_conv_s5__glu_gated_geglu__prompt_kernel,@function
parallel_sum__ssm_conv_s5__glu_gated_geglu__prompt_kernel:
  s_cmp_ge_u32 s2, 256
  s_cbranch_scc1 L_END
  s_load_dwordx16 s[40:55], s[0:1], 0
  s_load_dwordx16 s[56:71], s[0:1], 64
  v_and_b32 v1, 63, v0
  v_lshrrev_b32 v2, 6, v0
  s_and_b32 s76, s2, 7
  v_readfirstlane_b32 s36, v2
  s_lshr_b32 s82, s2, 3
  s_and_b32 s38, s76, 1
  s_lshl_b32 s38, s38, 3
  s_and_b32 s78, s82, 7
  s_add_u32 s38, s38, s78
  s_lshr_b32 s39, s76, 1
  s_lshl_b32 s39, s39, 2
  s_lshr_b32 s78, s82, 3
  s_add_u32 s39, s39, s78
  s_and_b32 s37, s36, 3
  s_lshl_b32 s72, s39, 1
  s_add_u32 s72, s72, s38
  s_and_b32 s72, s72, 7
  s_lshl_b32 s87, s76, 2
  s_and_b32 s78, s82, 3
  s_add_u32 s87, s87, s78
  s_lshr_b32 s88, s82, 2
  s_mul_i32 s78, s39, 3
  s_lshl_b32 s79, s39, 1
  s_add_u32 s79, s79, 11
  s_cmp_lt_u32 s39, 11
  s_cselect_b32 s73, s78, s79
  s_cselect_b32 s74, 64, 0x40000000
  s_lshl_b32 s73, s73, 6
  s_lshl_b32 s97, s37, 12
  s_lshl_b32 s83, s37, 11
  s_add_u32 s83, s83, 16384
  s_lshl_b32 s85, s37, 10
  v_lshrrev_b32 v2, 3, v1
  v_and_b32 v3, 7, v1
  v_lshrrev_b32 v17, 4, v1
  v_xor_b32 v18, v3, v17
  s_lshl_b32 s78, s38, 7
  s_lshl_b32 s79, s37, 5
  s_add_u32 s78, s78, s79
  v_add_u32 v19, s78, v2
  v_lshlrev_b32 v19, 10, v19
  v_lshl_add_u32 v13, v18, 4, v19
  v_xor_b32 v14, 64, v13
  v_add_u32 v14, 8192, v14
  s_and_b32 s80, s37, 1
  s_lshl_b32 s80, s80, 4
  s_lshl_b32 s79, s39, 5
  s_add_u32 s80, s80, s79
  v_add_u32 v19, s80, v2
  v_lshlrev_b32 v19, 10, v19
  v_lshl_add_u32 v15, v18, 4, v19
  v_xor_b32 v47, 64, v15
  v_add_u32 v47, 8192, v47
  v_lshrrev_b32 v19, 2, v1
  s_lshl_b32 s80, s37, 4
  v_add_u32 v19, s80, v19
  v_mul_u32_u24 v19, 2752, v19
  v_and_b32 v21, 3, v1
  v_lshl_add_u32 v16, v21, 4, v19
  v_lshlrev_b32 v20, 4, v1
  s_and_b32 s80, s36, 2
  s_waitcnt lgkmcnt(0)
  s_mov_b32 s4, s40
  s_and_b32 s5, s41, 0xffff
  s_mov_b32 s6, 2097152
  s_mov_b32 s7, 0x20000
  s_cmp_eq_u32 s80, 0
  s_cselect_b32 s46, s46, s48
  s_cselect_b32 s47, s47, s49
  s_cmp_lt_u32 s36, 4
  s_cselect_b32 s50, s50, s52
  s_cselect_b32 s51, s51, s53
  s_cmp_lt_u32 s36, 4
  s_cbranch_scc1 D0_1
  s_add_u32 s76, s72, 0
  s_and_b32 s76, s76, 7
  s_lshl_b32 s79, s76, 7
  s_add_u32 s80, s79, 16384
  s_add_u32 m0, s97, 0
  s_nop 0
  buffer_load_dwordx4 v13, s[4:7], s79 offen lds
  s_add_u32 m0, s97, 1024
  s_nop 0
  buffer_load_dwordx4 v14, s[4:7], s79 offen lds
  s_add_u32 m0, s97, 2048
  s_nop 0
  buffer_load_dwordx4 v13, s[4:7], s80 offen lds
  s_add_u32 m0, s97, 3072
  s_nop 0
  buffer_load_dwordx4 v14, s[4:7], s80 offen lds
  s_add_u32 s76, s72, 1
  s_and_b32 s76, s76, 7
  s_lshl_b32 s79, s76, 7
  s_add_u32 s80, s79, 16384
  s_add_u32 m0, s97, 32768
  s_nop 0
  buffer_load_dwordx4 v13, s[4:7], s79 offen lds
  s_add_u32 m0, s97, 33792
  s_nop 0
  buffer_load_dwordx4 v14, s[4:7], s79 offen lds
  s_add_u32 m0, s97, 34816
  s_nop 0
  buffer_load_dwordx4 v13, s[4:7], s80 offen lds
  s_add_u32 m0, s97, 35840
  s_nop 0
  buffer_load_dwordx4 v14, s[4:7], s80 offen lds
  s_mov_b32 s8, s46
  s_and_b32 s9, s47, 0xffff
  s_mov_b32 s10, 524288
  s_mov_b32 s11, 0x20000
  s_mov_b32 s12, s60
  s_and_b32 s13, s61, 0xffff
  s_mov_b32 s14, 1409024
  s_mov_b32 s15, 0x20000
  s_branch D1_2
D0_1:
  s_mov_b32 s8, s46
  s_and_b32 s9, s47, 0xffff
  s_mov_b32 s10, 524288
  s_mov_b32 s11, 0x20000
  s_mov_b32 s12, s60
  s_and_b32 s13, s61, 0xffff
  s_mov_b32 s14, 1409024
  s_mov_b32 s15, 0x20000
  s_mov_b32 s80, s62
  s_mov_b32 s81, s63
  s_mov_b32 s32, s80
  s_and_b32 s33, s81, 0xffff
  s_mov_b32 s34, 1409024
  s_mov_b32 s35, 0x20000
  s_add_u32 s76, s72, 0
  s_and_b32 s76, s76, 7
  s_lshl_b32 s79, s76, 7
  s_mul_i32 s78, s76, 176128
  s_add_u32 s78, s78, s73
  s_add_u32 m0, s83, 0
  s_nop 0
  buffer_load_dwordx4 v15, s[8:11], s79 offen lds
  s_add_u32 m0, s83, 1024
  s_nop 0
  buffer_load_dwordx4 v47, s[8:11], s79 offen lds
  s_add_u32 m0, s85, 24576
  s_nop 0
  buffer_load_dwordx4 v16, s[12:15], s78 offen lds
  s_add_u32 m0, s85, 28672
  s_nop 0
  buffer_load_dwordx4 v16, s[32:35], s78 offen lds
  s_lshl_b32 s78, s2, 3
  s_lshl_b32 s79, s37, 1
  s_add_u32 s81, s78, s79
  s_lshl_b32 s81, s81, 10
  buffer_load_dwordx4 v[64:67], v20, s[4:7], s81 offen
  buffer_load_dwordx4 v[68:71], v20, s[4:7], s81 offen offset:1024
  s_add_u32 s76, s72, 1
  s_and_b32 s76, s76, 7
  s_lshl_b32 s79, s76, 7
  s_mul_i32 s78, s76, 176128
  s_add_u32 s78, s78, s73
  s_add_u32 m0, s83, 32768
  s_nop 0
  buffer_load_dwordx4 v15, s[8:11], s79 offen lds
  s_add_u32 m0, s83, 33792
  s_nop 0
  buffer_load_dwordx4 v47, s[8:11], s79 offen lds
  s_add_u32 m0, s85, 57344
  s_nop 0
  buffer_load_dwordx4 v16, s[12:15], s78 offen lds
  s_add_u32 m0, s85, 61440
  s_nop 0
  buffer_load_dwordx4 v16, s[32:35], s78 offen lds
D1_2:
  s_mov_b32 s16, s70
  s_and_b32 s17, s71, 0xffff
  s_mov_b32 s18, 268435456
  s_mov_b32 s19, 0x20000
  s_add_u32 s48, s70, 11599872
  s_addc_u32 s49, s71, 0
  s_load_dword s75, s[48:49], 0
  s_mov_b32 s68, s62
  s_and_b32 s69, s63, 0xffff
  s_mov_b32 s70, 1409024
  s_mov_b32 s71, 0x20000
  s_mov_b32 s20, s64
  s_and_b32 s21, s65, 0xffff
  s_mov_b32 s22, 1409024
  s_mov_b32 s23, 0x20000
  s_mov_b32 s24, s50
  s_and_b32 s25, s51, 0xffff
  s_mov_b32 s26, 524288
  s_mov_b32 s27, 0x20000
  v_and_b32 v19, 31, v1
  s_lshl_b32 s80, s39, 5
  v_add_u32 v19, s80, v19
  v_lshlrev_b32 v19, 1, v19
  s_mov_b32 s32, s42
  s_and_b32 s33, s43, 0xffff
  s_mov_b32 s34, 1024
  s_mov_b32 s35, 0x20000
  buffer_load_ushort v36, v19, s[32:35], 0 offen
  s_mov_b32 s32, s44
  s_and_b32 s33, s45, 0xffff
  s_mov_b32 s34, 1024
  s_mov_b32 s35, 0x20000
  buffer_load_ushort v37, v19, s[32:35], 0 offen
  s_mov_b32 s32, s54
  s_and_b32 s33, s55, 0xffff
  s_mov_b32 s34, 1024
  s_mov_b32 s35, 0x20000
  buffer_load_ushort v38, v19, s[32:35], 0 offen
  s_mov_b32 s28, s66
  s_and_b32 s29, s67, 0xffff
  s_mov_b32 s30, 4194304
  s_mov_b32 s31, 0x20000
  s_mov_b32 s32, s56
  s_and_b32 s33, s57, 0xffff
  s_mov_b32 s34, 1024
  s_mov_b32 s35, 0x20000
  s_cmp_eq_u32 s36, 3
  s_cbranch_scc0 CP_3
  s_getpc_b64 s[78:79]
L_PC:
  s_mul_i32 s80, s82, 1280
  v_lshlrev_b32 v19, 7, v1
  v_add_u32 v19, s80, v19
  v_cmp_gt_u32 vcc, L_CODE_END-L_PC, v19
  s_and_saveexec_b64 s[92:93], vcc
  v_cmp_gt_u32 vcc, 10, v1
  s_and_b64 exec, exec, vcc
  s_cbranch_execz CP_3_R
  global_load_dword v46, v19, s[78:79]
CP_3_R:
  s_mov_b64 exec, s[92:93]
CP_3:
  s_lshr_b32 s79, s36, 1
  s_and_b32 s80, s36, 1
  s_lshl_b32 s80, s80, 14
  s_mul_i32 s98, s79, 98304
  s_add_u32 s98, s98, s80
  s_lshl_b32 s99, s79, 16
  s_add_u32 s99, s99, s80
  s_cmp_eq_u32 s79, 3
  s_cselect_b32 s96, 0x40000000, s98
  s_lshl_b32 s100, s37, 14
  s_lshl_b32 s89, s36, 11
  s_lshl_b32 s78, s38, 2
  s_add_u32 s78, s78, s37
  s_mul_i32 s101, s78, 153600
  s_lshl_b32 s80, s87, 1
  s_lshr_b32 s79, s36, 2
  s_add_u32 s80, s80, s79
  s_mul_i32 s80, s80, 153600
  s_lshl_b32 s79, s37, 11
  s_add_u32 s80, s80, s79
  v_lshlrev_b32 v42, 4, v1
  v_add_u32 v42, s80, v42
  v_bfe_u32 v19, v1, 4, 1
  v_lshlrev_b32 v19, 2, v19
  v_xor_b32 v19, v3, v19
  v_lshlrev_b32 v21, 10, v2
  v_lshl_add_u32 v19, v19, 4, v21
  s_lshl_b32 s80, s88, 7
  v_add_u32 v43, s80, v19
  s_lshl_b32 s80, s88, 6
  v_add_u32 v19, s80, v2
  v_lshlrev_b32 v19, 10, v19
  v_lshl_add_u32 v44, v18, 4, v19
  v_xor_b32 v45, 64, v44
  v_and_b32 v2, 31, v1
  v_bfe_u32 v3, v2, 2, 1
  v_lshlrev_b32 v3, 4, v3
  v_lshrrev_b32 v17, 3, v2
  v_lshl_add_u32 v3, v17, 2, v3
  v_and_b32 v18, 3, v2
  v_add_u32 v3, v3, v18
  v_bfe_u32 v17, v3, 1, 3
  s_lshl_b32 s80, s37, 5
  v_add_u32 v3, s80, v3
  v_lshlrev_b32 v3, 7, v3
  v_lshrrev_b32 v18, 5, v1
  v_xor_b32 v17, v17, v18
  v_lshl_add_u32 v4, v17, 4, v3
  v_xor_b32 v5, 32, v4
  v_xor_b32 v6, 64, v4
  v_xor_b32 v7, 96, v4
  v_lshlrev_b32 v3, 3, v18
  v_bfe_u32 v17, v1, 2, 2
  v_add_u32 v3, v3, v17
  v_lshlrev_b32 v3, 6, v3
  v_bfe_u32 v17, v1, 4, 1
  v_lshl_add_u32 v3, v17, 5, v3
  v_and_b32 v17, 3, v1
  v_lshl_add_u32 v0, v17, 3, v3
  s_lshr_b32 s80, s36, 2
  s_lshl_b32 s80, s80, 13
  v_add_u32 v12, s80, v0
  v_mov_b32 v2, s37
  s_cmp_ge_u32 s36, 4
  s_cbranch_scc1 L_STREAM_B
  s_waitcnt lgkmcnt(0)
  s_add_u32 s75, s75, 1
  v_and_b32 v3, 31, v1
  v_bfe_u32 v17, v3, 1, 3
  v_lshrrev_b32 v18, 5, v1
  v_xor_b32 v17, v17, v18
  v_lshlrev_b32 v3, 7, v3
  v_lshl_add_u32 v3, v17, 4, v3
  v_add_u32 v8, 16384, v3
  v_xor_b32 v9, 32, v8
  v_xor_b32 v10, 64, v8
  v_xor_b32 v11, 96, v8
  s_waitcnt vmcnt(7)
  s_lshl_b32 s78, s2, 3
  s_lshl_b32 s79, s37, 1
  s_add_u32 s81, s78, s79
  v_lshlrev_b32 v96, 16, v64
  v_and_b32 v97, 0xffff0000, v64
  v_lshlrev_b32 v98, 16, v65
  v_and_b32 v99, 0xffff0000, v65
  v_lshlrev_b32 v100, 16, v66
  v_and_b32 v101, 0xffff0000, v66
  v_lshlrev_b32 v102, 16, v67
  v_and_b32 v103, 0xffff0000, v67
  v_add_f32 v17, v96, v97
  v_add_f32 v18, v98, v99
  v_add_f32 v19, v100, v101
  v_add_f32 v21, v102, v103
  v_add_f32 v17, v17, v18
  v_add_f32 v19, v19, v21
  v_add_f32 v17, v17, v19
  s_nop 1
  v_add_f32_dpp v17, v17, v17 row_shr:1 row_mask:0xf bank_mask:0xf
  s_nop 1
  v_add_f32_dpp v17, v17, v17 row_shr:2 row_mask:0xf bank_mask:0xf
  s_nop 1
  v_add_f32_dpp v17, v17, v17 row_shr:4 row_mask:0xf bank_mask:0xf
  s_nop 1
  v_add_f32_dpp v17, v17, v17 row_shr:8 row_mask:0xf bank_mask:0xf
  s_nop 1
  v_add_f32_dpp v17, v17, v17 row_bcast:15 row_mask:0xa bank_mask:0xf
  s_nop 1
  v_add_f32_dpp v17, v17, v17 row_bcast:31 row_mask:0xc bank_mask:0xf
  s_nop 1
  v_readlane_b32 s80, v17, 63
  s_nop 1
  v_mov_b32 v18, s80
  v_mul_f32 v18, 989855744, v18
  v_mov_b32 v17, 0
  v_sub_f32 v19, v96, v18
  v_fmac_f32 v17, v19, v19
  v_sub_f32 v19, v97, v18
  v_fmac_f32 v17, v19, v19
  v_sub_f32 v19, v98, v18
  v_fmac_f32 v17, v19, v19
  v_sub_f32 v19, v99, v18
  v_fmac_f32 v17, v19, v19
  v_sub_f32 v19, v100, v18
  v_fmac_f32 v17, v19, v19
  v_sub_f32 v19, v101, v18
  v_fmac_f32 v17, v19, v19
  v_sub_f32 v19, v102, v18
  v_fmac_f32 v17, v19, v19
  v_sub_f32 v19, v103, v18
  v_fmac_f32 v17, v19, v19
  s_nop 1
  v_add_f32_dpp v17, v17, v17 row_shr:1 row_mask:0xf bank_mask:0xf
  s_nop 1
  v_add_f32_dpp v17, v17, v17 row_shr:2 row_mask:0xf bank_mask:0xf
  s_nop 1
  v_add_f32_dpp v17, v17, v17 row_shr:4 row_mask:0xf bank_mask:0xf
  s_nop 1
  v_add_f32_dpp v17, v17, v17 row_shr:8 row_mask:0xf bank_mask:0xf
  s_nop 1
  v_add_f32_dpp v17, v17, v17 row_bcast:15 row_mask:0xa bank_mask:0xf
  s_nop 1
  v_add_f32_dpp v17, v17, v17 row_bcast:31 row_mask:0xc bank_mask:0xf
  s_nop 1
  v_readlane_b32 s80, v17, 63
  s_nop 1
  v_mov_b32 v19, s80
  v_mul_f32 v19, 989855744, v19
  v_cvt_pk_bf16_f32 v18, v18, v18
  v_lshlrev_b32 v18, 16, v18
  v_cvt_pk_bf16_f32 v19, v19, v19
  v_lshlrev_b32 v19, 16, v19
  v_add_f32 v19, 925353388, v19
  v_cvt_pk_bf16_f32 v19, v19, v19
  v_lshlrev_b32 v19, 16, v19
  v_sqrt_f32 v19, v19
  s_nop 0
  v_cvt_pk_bf16_f32 v19, v19, v19
  v_lshlrev_b32 v19, 16, v19
  v_mov_b32 v96, v18
  v_mov_b32 v97, s75
  v_mov_b32 v98, v19
  v_mov_b32 v99, s75
  s_lshl_b32 s80, s81, 4
  s_add_u32 s80, s80, 10747904
  v_mov_b32 v17, 0
  s_mov_b64 s[92:93], exec
  s_mov_b64 exec, 1
  buffer_store_dwordx4 v[96:99], v17, s[16:19], s80 offen sc1
  s_mov_b64 exec, s[92:93]
  s_add_u32 s81, s81, 1
  v_lshlrev_b32 v96, 16, v68
  v_and_b32 v97, 0xffff0000, v68
  v_lshlrev_b32 v98, 16, v69
  v_and_b32 v99, 0xffff0000, v69
  v_lshlrev_b32 v100, 16, v70
  v_and_b32 v101, 0xffff0000, v70
  v_lshlrev_b32 v102, 16, v71
  v_and_b32 v103, 0xffff0000, v71
  v_add_f32 v17, v96, v97
  v_add_f32 v18, v98, v99
  v_add_f32 v19, v100, v101
  v_add_f32 v21, v102, v103
  v_add_f32 v17, v17, v18
  v_add_f32 v19, v19, v21
  v_add_f32 v17, v17, v19
  s_nop 1
  v_add_f32_dpp v17, v17, v17 row_shr:1 row_mask:0xf bank_mask:0xf
  s_nop 1
  v_add_f32_dpp v17, v17, v17 row_shr:2 row_mask:0xf bank_mask:0xf
  s_nop 1
  v_add_f32_dpp v17, v17, v17 row_shr:4 row_mask:0xf bank_mask:0xf
  s_nop 1
  v_add_f32_dpp v17, v17, v17 row_shr:8 row_mask:0xf bank_mask:0xf
  s_nop 1
  v_add_f32_dpp v17, v17, v17 row_bcast:15 row_mask:0xa bank_mask:0xf
  s_nop 1
  v_add_f32_dpp v17, v17, v17 row_bcast:31 row_mask:0xc bank_mask:0xf
  s_nop 1
  v_readlane_b32 s80, v17, 63
  s_nop 1
  v_mov_b32 v18, s80
  v_mul_f32 v18, 989855744, v18
  v_mov_b32 v17, 0
  v_sub_f32 v19, v96, v18
  v_fmac_f32 v17, v19, v19
  v_sub_f32 v19, v97, v18
  v_fmac_f32 v17, v19, v19
  v_sub_f32 v19, v98, v18
  v_fmac_f32 v17, v19, v19
  v_sub_f32 v19, v99, v18
  v_fmac_f32 v17, v19, v19
  v_sub_f32 v19, v100, v18
  v_fmac_f32 v17, v19, v19
  v_sub_f32 v19, v101, v18
  v_fmac_f32 v17, v19, v19
  v_sub_f32 v19, v102, v18
  v_fmac_f32 v17, v19, v19
  v_sub_f32 v19, v103, v18
  v_fmac_f32 v17, v19, v19
  s_nop 1
  v_add_f32_dpp v17, v17, v17 row_shr:1 row_mask:0xf bank_mask:0xf
  s_nop 1
  v_add_f32_dpp v17, v17, v17 row_shr:2 row_mask:0xf bank_mask:0xf
  s_nop 1
  v_add_f32_dpp v17, v17, v17 row_shr:4 row_mask:0xf bank_mask:0xf
  s_nop 1
  v_add_f32_dpp v17, v17, v17 row_shr:8 row_mask:0xf bank_mask:0xf
  s_nop 1
  v_add_f32_dpp v17, v17, v17 row_bcast:15 row_mask:0xa bank_mask:0xf
  s_nop 1
  v_add_f32_dpp v17, v17, v17 row_bcast:31 row_mask:0xc bank_mask:0xf
  s_nop 1
  v_readlane_b32 s80, v17, 63
  s_nop 1
  v_mov_b32 v19, s80
  v_mul_f32 v19, 989855744, v19
  v_cvt_pk_bf16_f32 v18, v18, v18
  v_lshlrev_b32 v18, 16, v18
  v_cvt_pk_bf16_f32 v19, v19, v19
  v_lshlrev_b32 v19, 16, v19
  v_add_f32 v19, 925353388, v19
  v_cvt_pk_bf16_f32 v19, v19, v19
  v_lshlrev_b32 v19, 16, v19
  v_sqrt_f32 v19, v19
  s_nop 0
  v_cvt_pk_bf16_f32 v19, v19, v19
  v_lshlrev_b32 v19, 16, v19
  v_mov_b32 v96, v18
  v_mov_b32 v97, s75
  v_mov_b32 v98, v19
  v_mov_b32 v99, s75
  s_lshl_b32 s80, s81, 4
  s_add_u32 s80, s80, 10747904
  v_mov_b32 v17, 0
  s_mov_b64 s[92:93], exec
  s_mov_b64 exec, 1
  buffer_store_dwordx4 v[96:99], v17, s[16:19], s80 offen sc1
  s_mov_b64 exec, s[92:93]
  s_lshr_b32 s86, s38, 3
  s_add_u32 s86, s86, 1
  s_cmp_eq_u32 s37, 0
  s_cselect_b32 s86, s86, 0
  v_mov_b32 v28, 0x3f803f80
  v_mov_b32 v29, 0x3f803f80
  v_mov_b32 v30, 0x3f803f80
  v_mov_b32 v31, 0x3f803f80
  v_mov_b32 v64, 0
  v_mov_b32 v65, 0
  v_mov_b32 v66, 0
  v_mov_b32 v67, 0
  v_mov_b32 v68, 0
  v_mov_b32 v69, 0
  v_mov_b32 v70, 0
  v_mov_b32 v71, 0
  v_mov_b32 v72, 0
  v_mov_b32 v73, 0
  v_mov_b32 v74, 0
  v_mov_b32 v75, 0
  v_mov_b32 v76, 0
  v_mov_b32 v77, 0
  v_mov_b32 v78, 0
  v_mov_b32 v79, 0
  v_mov_b32 v80, 0
  v_mov_b32 v81, 0
  v_mov_b32 v82, 0
  v_mov_b32 v83, 0
  v_mov_b32 v84, 0
  v_mov_b32 v85, 0
  v_mov_b32 v86, 0
  v_mov_b32 v87, 0
  v_mov_b32 v88, 0
  v_mov_b32 v89, 0
  v_mov_b32 v90, 0
  v_mov_b32 v91, 0
  v_mov_b32 v92, 0
  v_mov_b32 v93, 0
  v_mov_b32 v94, 0
  v_mov_b32 v95, 0
  v_mov_b32 v96, 0
  v_mov_b32 v97, 0
  v_mov_b32 v98, 0
  v_mov_b32 v99, 0
  v_mov_b32 v100, 0
  v_mov_b32 v101, 0
  v_mov_b32 v102, 0
  v_mov_b32 v103, 0
  v_mov_b32 v104, 0
  v_mov_b32 v105, 0
  v_mov_b32 v106, 0
  v_mov_b32 v107, 0
  v_mov_b32 v108, 0
  v_mov_b32 v109, 0
  v_mov_b32 v110, 0
  v_mov_b32 v111, 0
  v_mov_b32 v112, 0
  v_mov_b32 v113, 0
  v_mov_b32 v114, 0
  v_mov_b32 v115, 0
  v_mov_b32 v116, 0
  v_mov_b32 v117, 0
  v_mov_b32 v118, 0
  v_mov_b32 v119, 0
  v_mov_b32 v120, 0
  v_mov_b32 v121, 0
  v_mov_b32 v122, 0
  v_mov_b32 v123, 0
  v_mov_b32 v124, 0
  v_mov_b32 v125, 0
  v_mov_b32 v126, 0
  v_mov_b32 v127, 0
  s_barrier
  ds_read_b128 v[128:131], v4 offset:0
  ds_read_b128 v[132:135], v5 offset:0
  ds_read_b128 v[136:139], v6 offset:0
  ds_read_b128 v[140:143], v7 offset:0
  ds_read_b128 v[48:51], v8 offset:0
  ds_read_b128 v[52:55], v8 offset:4096
  ds_read_b128 v[56:59], v9 offset:0
  s_waitcnt lgkmcnt(6)
  s_waitcnt lgkmcnt(2)
  v_mfma_f32_32x32x16_bf16 v[64:79], v[128:131], v[48:51], v[64:79]
  s_cmp_eq_u32 s86, 1
  s_cbranch_scc0 CSK_4
  v_mfma_f32_32x32x16_bf16 v[96:111], v[28:31], v[48:51], 0
CSK_4:
  ds_read_b128 v[60:63], v9 offset:4096
  s_add_u32 s76, s72, 2
  s_and_b32 s76, s76, 7
  s_lshl_b32 s79, s76, 7
  s_mul_i32 s78, s76, 176128
  s_add_u32 s78, s78, s73
  s_add_u32 m0, s83, 65536
  s_nop 0
  buffer_load_dwordx4 v15, s[8:11], s79 offen lds
  s_waitcnt lgkmcnt(2)
  v_mfma_f32_32x32x16_bf16 v[80:95], v[128:131], v[52:55], v[80:95]
  s_cmp_eq_u32 s86, 2
  s_cbranch_scc0 CSK_5
  v_mfma_f32_32x32x16_bf16 v[96:111], v[28:31], v[52:55], 0
CSK_5:
  ds_read_b128 v[48:51], v10 offset:0
  s_waitcnt lgkmcnt(2)
  v_mfma_f32_32x32x16_bf16 v[64:79], v[132:135], v[56:59], v[64:79]
  s_cmp_eq_u32 s86, 1
  s_cbranch_scc0 CSK_6
  v_mfma_f32_32x32x16_bf16 v[96:111], v[28:31], v[56:59], v[96:111]
CSK_6:
  ds_read_b128 v[52:55], v10 offset:4096
  s_add_u32 m0, s83, 66560
  s_nop 0
  buffer_load_dwordx4 v47, s[8:11], s79 offen lds
  s_waitcnt lgkmcnt(2)
  v_mfma_f32_32x32x16_bf16 v[80:95], v[132:135], v[60:63], v[80:95]
  s_cmp_eq_u32 s86, 2
  s_cbranch_scc0 CSK_7
  v_mfma_f32_32x32x16_bf16 v[96:111], v[28:31], v[60:63], v[96:111]
CSK_7:
  ds_read_b128 v[56:59], v11 offset:0
  s_waitcnt lgkmcnt(2)
  v_mfma_f32_32x32x16_bf16 v[64:79], v[136:139], v[48:51], v[64:79]
  s_cmp_eq_u32 s86, 1
  s_cbranch_scc0 CSK_8
  v_mfma_f32_32x32x16_bf16 v[96:111], v[28:31], v[48:51], v[96:111]
CSK_8:
  ds_read_b128 v[60:63], v11 offset:4096
  s_add_u32 m0, s85, 90112
  s_nop 0
  buffer_load_dwordx4 v16, s[12:15], s78 offen lds
  s_waitcnt lgkmcnt(2)
  v_mfma_f32_32x32x16_bf16 v[80:95], v[136:139], v[52:55], v[80:95]
  s_cmp_eq_u32 s86, 2
  s_cbranch_scc0 CSK_9
  v_mfma_f32_32x32x16_bf16 v[96:111], v[28:31], v[52:55], v[96:111]
CSK_9:
  s_waitcnt vmcnt(8)
  s_barrier
  ds_read_b128 v[144:147], v4 offset:32768
  ds_read_b128 v[148:151], v5 offset:32768
  ds_read_b128 v[152:155], v6 offset:32768
  ds_read_b128 v[156:159], v7 offset:32768
  ds_read_b128 v[48:51], v8 offset:32768
  s_add_u32 m0, s85, 94208
  s_nop 0
  buffer_load_dwordx4 v16, s[68:71], s78 offen lds
  s_add_u32 s76, s72, 3
  s_and_b32 s76, s76, 7
  s_lshl_b32 s79, s76, 7
  s_mul_i32 s78, s76, 176128
  s_add_u32 s78, s78, s73
  s_add_u32 m0, s83, 98304
  s_nop 0
  buffer_load_dwordx4 v15, s[8:11], s79 offen lds
  s_waitcnt lgkmcnt(6)
  v_mfma_f32_32x32x16_bf16 v[64:79], v[140:143], v[56:59], v[64:79]
  s_cmp_eq_u32 s86, 1
  s_cbranch_scc0 CSK_10
  v_mfma_f32_32x32x16_bf16 v[96:111], v[28:31], v[56:59], v[96:111]
CSK_10:
  ds_read_b128 v[52:55], v8 offset:36864
  s_add_u32 m0, s83, 99328
  s_nop 0
  buffer_load_dwordx4 v47, s[8:11], s79 offen lds
  s_waitcnt lgkmcnt(6)
  v_mfma_f32_32x32x16_bf16 v[80:95], v[140:143], v[60:63], v[80:95]
  s_cmp_eq_u32 s86, 2
  s_cbranch_scc0 CSK_11
  v_mfma_f32_32x32x16_bf16 v[96:111], v[28:31], v[60:63], v[96:111]
CSK_11:
  ds_read_b128 v[56:59], v9 offset:32768
  s_nop 7
  s_nop 7
  s_add_u32 s77, s72, 0
  s_and_b32 s77, s77, 7
  s_lshl_b32 s76, s39, 3
  s_add_u32 s76, s76, s77
  s_lshl_b32 s76, s76, 11
  s_sub_u32 s77, s86, 1
  s_lshl_b32 s77, s77, 8
  s_add_u32 s76, s76, s77
  s_add_u32 s76, s76, 11010048
  s_lshl_b32 s77, s2, 11
  s_add_u32 s77, s77, 11665408
  s_cmp_eq_u32 s86, 0
  s_cselect_b32 s76, s77, s76
  v_mov_b32 v97, s75
  v_lshlrev_b32 v98, 3, v1
  s_mov_b64 s[92:93], exec
  s_mov_b64 exec, 0xffffffff
  buffer_store_dwordx2 v[96:97], v98, s[16:19], s76 offen sc1
  s_mov_b64 exec, s[92:93]
  s_nop 7
  v_mov_b32 v96, 0
  v_mov_b32 v97, 0
  v_mov_b32 v98, 0
  v_mov_b32 v99, 0
  v_mov_b32 v100, 0
  v_mov_b32 v101, 0
  v_mov_b32 v102, 0
  v_mov_b32 v103, 0
  v_mov_b32 v104, 0
  v_mov_b32 v105, 0
  v_mov_b32 v106, 0
  v_mov_b32 v107, 0
  v_mov_b32 v108, 0
  v_mov_b32 v109, 0
  v_mov_b32 v110, 0
  v_mov_b32 v111, 0
  s_waitcnt lgkmcnt(6)
  s_waitcnt lgkmcnt(2)
  v_mfma_f32_32x32x16_bf16 v[64:79], v[144:147], v[48:51], v[64:79]
  ds_read_b128 v[60:63], v9 offset:36864
  s_add_u32 m0, s85, 122880
  s_nop 0
  buffer_load_dwordx4 v16, s[12:15], s78 offen lds
  s_waitcnt lgkmcnt(2)
  v_mfma_f32_32x32x16_bf16 v[80:95], v[144:147], v[52:55], v[80:95]
  ds_read_b128 v[48:51], v10 offset:32768
  s_waitcnt lgkmcnt(2)
  v_mfma_f32_32x32x16_bf16 v[64:79], v[148:151], v[56:59], v[64:79]
  ds_read_b128 v[52:55], v10 offset:36864
  s_add_u32 m0, s85, 126976
  s_nop 0
  buffer_load_dwordx4 v16, s[68:71], s78 offen lds
  s_waitcnt lgkmcnt(2)
  v_mfma_f32_32x32x16_bf16 v[80:95], v[148:151], v[60:63], v[80:95]
  ds_read_b128 v[56:59], v11 offset:32768
  s_waitcnt lgkmcnt(2)
  v_mfma_f32_32x32x16_bf16 v[64:79], v[152:155], v[48:51], v[64:79]
  ds_read_b128 v[60:63], v11 offset:36864
  s_waitcnt lgkmcnt(2)
  v_mfma_f32_32x32x16_bf16 v[80:95], v[152:155], v[52:55], v[80:95]
  s_waitcnt vmcnt(5)
  s_barrier
  v_xor_b32 v4, 0x10000, v4
  v_xor_b32 v5, 0x10000, v5
  v_xor_b32 v6, 0x10000, v6
  v_xor_b32 v7, 0x10000, v7
  v_xor_b32 v8, 0x10000, v8
  v_xor_b32 v9, 0x10000, v9
  v_xor_b32 v10, 0x10000, v10
  v_xor_b32 v11, 0x10000, v11
  ds_read_b128 v[160:163], v4 offset:0
  ds_read_b128 v[164:167], v5 offset:0
  ds_read_b128 v[168:171], v6 offset:0
  ds_read_b128 v[172:175], v7 offset:0
  ds_read_b128 v[48:51], v8 offset:0
  s_waitcnt lgkmcnt(6)
  v_mfma_f32_32x32x16_bf16 v[64:79], v[156:159], v[56:59], v[64:79]
  ds_read_b128 v[52:55], v8 offset:4096
  s_add_u32 s76, s72, 4
  s_and_b32 s76, s76, 7
  s_lshl_b32 s79, s76, 7
  s_mul_i32 s78, s76, 176128
  s_add_u32 s78, s78, s73
  s_add_u32 m0, s83, 0
  s_nop 0
  buffer_load_dwordx4 v15, s[8:11], s79 offen lds
  s_waitcnt lgkmcnt(6)
  v_mfma_f32_32x32x16_bf16 v[80:95], v[156:159], v[60:63], v[80:95]
  ds_read_b128 v[56:59], v9 offset:0
  s_waitcnt lgkmcnt(6)
  s_waitcnt lgkmcnt(2)
  v_mfma_f32_32x32x16_bf16 v[64:79], v[160:163], v[48:51], v[64:79]
  ds_read_b128 v[60:63], v9 offset:4096
  s_add_u32 m0, s83, 1024
  s_nop 0
  buffer_load_dwordx4 v47, s[8:11], s79 offen lds
  s_waitcnt lgkmcnt(2)
  v_mfma_f32_32x32x16_bf16 v[80:95], v[160:163], v[52:55], v[80:95]
  ds_read_b128 v[48:51], v10 offset:0
  s_waitcnt lgkmcnt(2)
  v_mfma_f32_32x32x16_bf16 v[64:79], v[164:167], v[56:59], v[64:79]
  ds_read_b128 v[52:55], v10 offset:4096
  s_add_u32 m0, s85, 24576
  s_nop 0
  buffer_load_dwordx4 v16, s[12:15], s78 offen lds
  s_waitcnt lgkmcnt(2)
  v_mfma_f32_32x32x16_bf16 v[80:95], v[164:167], v[60:63], v[80:95]
  ds_read_b128 v[56:59], v11 offset:0
  s_waitcnt lgkmcnt(2)
  v_mfma_f32_32x32x16_bf16 v[64:79], v[168:171], v[48:51], v[64:79]
  ds_read_b128 v[60:63], v11 offset:4096
  s_add_u32 m0, s85, 28672
  s_nop 0
  buffer_load_dwordx4 v16, s[68:71], s78 offen lds
  s_waitcnt lgkmcnt(2)
  v_mfma_f32_32x32x16_bf16 v[80:95], v[168:171], v[52:55], v[80:95]
  s_waitcnt vmcnt(4)
  s_barrier
  ds_read_b128 v[176:179], v4 offset:32768
  ds_read_b128 v[180:183], v5 offset:32768
  ds_read_b128 v[184:187], v6 offset:32768
  ds_read_b128 v[188:191], v7 offset:32768
  ds_read_b128 v[48:51], v8 offset:32768
  s_waitcnt lgkmcnt(6)
  v_mfma_f32_32x32x16_bf16 v[64:79], v[172:175], v[56:59], v[64:79]
  ds_read_b128 v[52:55], v8 offset:36864
  s_add_u32 s76, s72, 5
  s_and_b32 s76, s76, 7
  s_lshl_b32 s79, s76, 7
  s_mul_i32 s78, s76, 176128
  s_add_u32 s78, s78, s73
  s_add_u32 m0, s83, 32768
  s_nop 0
  buffer_load_dwordx4 v15, s[8:11], s79 offen lds
  s_waitcnt lgkmcnt(6)
  v_mfma_f32_32x32x16_bf16 v[80:95], v[172:175], v[60:63], v[80:95]
  ds_read_b128 v[56:59], v9 offset:32768
  s_waitcnt lgkmcnt(6)
  s_waitcnt lgkmcnt(2)
  v_mfma_f32_32x32x16_bf16 v[64:79], v[176:179], v[48:51], v[64:79]
  ds_read_b128 v[60:63], v9 offset:36864
  s_add_u32 m0, s83, 33792
  s_nop 0
  buffer_load_dwordx4 v47, s[8:11], s79 offen lds
  v_lshlrev_b32 v24, 16, v36
  v_lshlrev_b32 v25, 16, v37
  v_lshlrev_b32 v26, 16, v38
  s_waitcnt lgkmcnt(2)
  v_mfma_f32_32x32x16_bf16 v[80:95], v[176:179], v[52:55], v[80:95]
  ds_read_b128 v[48:51], v10 offset:32768
  v_mul_f32 v17, 1069066811, v26
  v_exp_f32 v17, v17
  s_nop 0
  s_waitcnt lgkmcnt(2)
  v_mfma_f32_32x32x16_bf16 v[64:79], v[180:183], v[56:59], v[64:79]
  ds_read_b128 v[52:55], v10 offset:36864
  s_add_u32 m0, s85, 57344
  s_nop 0
  buffer_load_dwordx4 v16, s[12:15], s78 offen lds
  v_cvt_pk_bf16_f32 v17, v17, v17
  v_lshlrev_b32 v17, 16, v17
  v_mul_f32 v18, v17, v24
  s_waitcnt lgkmcnt(2)
  v_mfma_f32_32x32x16_bf16 v[80:95], v[180:183], v[60:63], v[80:95]
  ds_read_b128 v[56:59], v11 offset:32768
  v_mul_f32 v19, v17, v25
  v_mul_f32 v18, 1069066811, v18
  v_exp_f32 v18, v18
  s_waitcnt lgkmcnt(2)
  v_mfma_f32_32x32x16_bf16 v[64:79], v[184:187], v[48:51], v[64:79]
  ds_read_b128 v[60:63], v11 offset:36864
  s_add_u32 m0, s85, 61440
  s_nop 0
  buffer_load_dwordx4 v16, s[68:71], s78 offen lds
  v_mul_f32 v19, 1042479491, v19
  v_rndne_f32 v20, v19
  v_sub_f32 v19, v19, v20
  s_waitcnt lgkmcnt(2)
  v_mfma_f32_32x32x16_bf16 v[80:95], v[184:187], v[52:55], v[80:95]
  s_waitcnt vmcnt(4)
  s_barrier
  v_xor_b32 v4, 0x10000, v4
  v_xor_b32 v5, 0x10000, v5
  v_xor_b32 v6, 0x10000, v6
  v_xor_b32 v7, 0x10000, v7
  v_xor_b32 v8, 0x10000, v8
  v_xor_b32 v9, 0x10000, v9
  v_xor_b32 v10, 0x10000, v10
  v_xor_b32 v11, 0x10000, v11
  ds_read_b128 v[192:195], v4 offset:0
  ds_read_b128 v[196:199], v5 offset:0
  ds_read_b128 v[200:203], v6 offset:0
  ds_read_b128 v[204:207], v7 offset:0
  ds_read_b128 v[48:51], v8 offset:0
  v_cos_f32 v20, v19
  v_sin_f32 v21, v19
  s_nop 0
  s_waitcnt lgkmcnt(6)
  v_mfma_f32_32x32x16_bf16 v[64:79], v[188:191], v[56:59], v[64:79]
  ds_read_b128 v[52:55], v8 offset:4096
  s_add_u32 s76, s72, 6
  s_and_b32 s76, s76, 7
  s_lshl_b32 s79, s76, 7
  s_mul_i32 s78, s76, 176128
  s_add_u32 s78, s78, s73
  s_add_u32 m0, s83, 65536
  s_nop 0
  buffer_load_dwordx4 v15, s[8:11], s79 offen lds
  v_mul_f32 v32, v18, v20
  v_mul_f32 v33, v18, v21
  v_add_f32 v20, -1.0, v32
  s_waitcnt lgkmcnt(6)
  v_mfma_f32_32x32x16_bf16 v[80:95], v[188:191], v[60:63], v[80:95]
  ds_read_b128 v[56:59], v9 offset:0
  v_mul_f32 v21, v24, v24
  v_fmac_f32 v21, v25, v25
  v_rcp_f32 v21, v21
  s_waitcnt lgkmcnt(6)
  s_waitcnt lgkmcnt(2)
  v_mfma_f32_32x32x16_bf16 v[64:79], v[192:195], v[48:51], v[64:79]
  ds_read_b128 v[60:63], v9 offset:4096
  s_add_u32 m0, s83, 66560
  s_nop 0
  buffer_load_dwordx4 v47, s[8:11], s79 offen lds
  v_mul_f32 v22, v20, v24
  v_fmac_f32 v22, v33, v25
  v_mul_f32 v23, v33, v24
  s_waitcnt lgkmcnt(2)
  v_mfma_f32_32x32x16_bf16 v[80:95], v[192:195], v[52:55], v[80:95]
  ds_read_b128 v[48:51], v10 offset:0
  v_fma_f32 v23, -v20, v25, v23
  v_add_f32 v21, v21, v21
  v_mul_f32 v34, v22, v21
  s_waitcnt lgkmcnt(2)
  v_mfma_f32_32x32x16_bf16 v[64:79], v[196:199], v[56:59], v[64:79]
  ds_read_b128 v[52:55], v10 offset:4096
  s_add_u32 m0, s85, 90112
  s_nop 0
  buffer_load_dwordx4 v16, s[12:15], s78 offen lds
  v_mul_f32 v35, v23, v21
  v_mov_b32 v36, v32
  v_mov_b32 v37, v33
  s_waitcnt lgkmcnt(2)
  v_mfma_f32_32x32x16_bf16 v[80:95], v[196:199], v[60:63], v[80:95]
  ds_read_b128 v[56:59], v11 offset:0
  v_mul_f32 v17, v37, v37
  v_mul_f32 v18, v36, v37
  v_fma_f32 v36, v36, v36, -v17
  s_waitcnt lgkmcnt(2)
  v_mfma_f32_32x32x16_bf16 v[64:79], v[200:203], v[48:51], v[64:79]
  ds_read_b128 v[60:63], v11 offset:4096
  s_add_u32 m0, s85, 94208
  s_nop 0
  buffer_load_dwordx4 v16, s[68:71], s78 offen lds
  v_add_f32 v37, v18, v18
  v_mul_f32 v17, v37, v37
  v_mul_f32 v18, v36, v37
  s_waitcnt lgkmcnt(2)
  v_mfma_f32_32x32x16_bf16 v[80:95], v[200:203], v[52:55], v[80:95]
  s_waitcnt vmcnt(4)
  s_barrier
  ds_read_b128 v[208:211], v4 offset:32768
  ds_read_b128 v[212:215], v5 offset:32768
  ds_read_b128 v[216:219], v6 offset:32768
  ds_read_b128 v[220:223], v7 offset:32768
  ds_read_b128 v[48:51], v8 offset:32768
  v_fma_f32 v36, v36, v36, -v17
  v_add_f32 v37, v18, v18
  v_mul_f32 v17, v37, v37
  s_waitcnt lgkmcnt(6)
  v_mfma_f32_32x32x16_bf16 v[64:79], v[204:207], v[56:59], v[64:79]
  ds_read_b128 v[52:55], v8 offset:36864
  s_add_u32 s76, s72, 7
  s_and_b32 s76, s76, 7
  s_lshl_b32 s79, s76, 7
  s_mul_i32 s78, s76, 176128
  s_add_u32 s78, s78, s73
  s_add_u32 m0, s83, 98304
  s_nop 0
  buffer_load_dwordx4 v15, s[8:11], s79 offen lds
  v_mul_f32 v18, v36, v37
  v_fma_f32 v36, v36, v36, -v17
  v_add_f32 v37, v18, v18
  s_waitcnt lgkmcnt(6)
  v_mfma_f32_32x32x16_bf16 v[80:95], v[204:207], v[60:63], v[80:95]
  ds_read_b128 v[56:59], v9 offset:32768
  v_mul_f32 v17, v37, v37
  v_mul_f32 v18, v36, v37
  v_fma_f32 v36, v36, v36, -v17
  s_waitcnt lgkmcnt(6)
  s_waitcnt lgkmcnt(2)
  v_mfma_f32_32x32x16_bf16 v[64:79], v[208:211], v[48:51], v[64:79]
  ds_read_b128 v[60:63], v9 offset:36864
  s_add_u32 m0, s83, 99328
  s_nop 0
  buffer_load_dwordx4 v47, s[8:11], s79 offen lds
  v_add_f32 v37, v18, v18
  v_mov_b32 v38, v36
  v_mov_b32 v39, v37
  s_waitcnt lgkmcnt(2)
  v_mfma_f32_32x32x16_bf16 v[80:95], v[208:211], v[52:55], v[80:95]
  ds_read_b128 v[48:51], v10 offset:32768
  v_mul_f32 v17, v39, v39
  v_mul_f32 v18, v38, v39
  v_fma_f32 v38, v38, v38, -v17
  s_waitcnt lgkmcnt(2)
  v_mfma_f32_32x32x16_bf16 v[64:79], v[212:215], v[56:59], v[64:79]
  ds_read_b128 v[52:55], v10 offset:36864
  s_add_u32 m0, s85, 122880
  s_nop 0
  buffer_load_dwordx4 v16, s[12:15], s78 offen lds
  v_add_f32 v39, v18, v18
  v_mul_f32 v17, v39, v39
  v_mul_f32 v18, v38, v39
  s_waitcnt lgkmcnt(2)
  v_mfma_f32_32x32x16_bf16 v[80:95], v[212:215], v[60:63], v[80:95]
  ds_read_b128 v[56:59], v11 offset:32768
  v_fma_f32 v38, v38, v38, -v17
  v_add_f32 v39, v18, v18
  v_mul_f32 v17, v39, v39
  s_waitcnt lgkmcnt(2)
  v_mfma_f32_32x32x16_bf16 v[64:79], v[216:219], v[48:51], v[64:79]
  ds_read_b128 v[60:63], v11 offset:36864
  s_add_u32 m0, s85, 126976
  s_nop 0
  buffer_load_dwordx4 v16, s[68:71], s78 offen lds
  v_mul_f32 v18, v38, v39
  v_fma_f32 v38, v38, v38, -v17
  v_add_f32 v39, v18, v18
  s_waitcnt lgkmcnt(2)
  v_mfma_f32_32x32x16_bf16 v[80:95], v[216:219], v[52:55], v[80:95]
  s_waitcnt vmcnt(4)
  s_barrier
  v_xor_b32 v4, 0x10000, v4
  v_xor_b32 v5, 0x10000, v5
  v_xor_b32 v6, 0x10000, v6
  v_xor_b32 v7, 0x10000, v7
  v_xor_b32 v8, 0x10000, v8
  v_xor_b32 v9, 0x10000, v9
  v_xor_b32 v10, 0x10000, v10
  v_xor_b32 v11, 0x10000, v11
  ds_read_b128 v[224:227], v4 offset:0
  ds_read_b128 v[228:231], v5 offset:0
  ds_read_b128 v[232:235], v6 offset:0
  ds_read_b128 v[236:239], v7 offset:0
  ds_read_b128 v[48:51], v8 offset:0
  s_waitcnt lgkmcnt(6)
  v_mfma_f32_32x32x16_bf16 v[64:79], v[220:223], v[56:59], v[64:79]
  ds_read_b128 v[52:55], v8 offset:4096
  s_add_u32 s76, s72, 0
  s_and_b32 s76, s76, 7
  s_mul_i32 s78, s76, 176128
  s_add_u32 s78, s78, s73
  s_add_u32 s78, s78, 64
  s_add_u32 s79, s78, s74
  s_add_u32 m0, s85, 0
  s_nop 0
  buffer_load_dwordx4 v16, s[12:15], s78 offen lds
  s_waitcnt lgkmcnt(6)
  v_mfma_f32_32x32x16_bf16 v[80:95], v[220:223], v[60:63], v[80:95]
  ds_read_b128 v[56:59], v9 offset:0
  s_cmp_lt_u32 s37, 2
  s_cbranch_scc0 G_12
  s_lshl_b32 s76, s39, 14
  s_add_u32 s76, s76, 11010048
  s_lshl_b32 s77, s37, 9
  s_add_u32 s76, s76, s77
  v_lshlrev_b32 v3, 3, v1
  s_add_u32 s77, s76, 0
  buffer_load_dwordx2 v[112:113], v3, s[16:19], s77 offen offset:0 sc1
  s_add_u32 s77, s76, 0
  buffer_load_dwordx2 v[114:115], v3, s[16:19], s77 offen offset:2048 sc1
  s_add_u32 s77, s76, 4096
  buffer_load_dwordx2 v[116:117], v3, s[16:19], s77 offen offset:0 sc1
  s_add_u32 s77, s76, 4096
  buffer_load_dwordx2 v[118:119], v3, s[16:19], s77 offen offset:2048 sc1
  s_add_u32 s77, s76, 8192
  buffer_load_dwordx2 v[120:121], v3, s[16:19], s77 offen offset:0 sc1
  s_add_u32 s77, s76, 8192
  buffer_load_dwordx2 v[122:123], v3, s[16:19], s77 offen offset:2048 sc1
  s_add_u32 s77, s76, 12288
  buffer_load_dwordx2 v[124:125], v3, s[16:19], s77 offen offset:0 sc1
  s_add_u32 s77, s76, 12288
  buffer_load_dwordx2 v[126:127], v3, s[16:19], s77 offen offset:2048 sc1
  s_branch G_13
G_12:
  s_lshl_b32 s76, s38, 11
  s_sub_u32 s77, s37, 2
  s_lshl_b32 s77, s77, 10
  s_add_u32 s76, s76, s77
  s_add_u32 s76, s76, 10747904
  v_lshlrev_b32 v3, 4, v1
  buffer_load_dwordx4 v[112:115], v3, s[16:19], s76 offen sc1
  s_mov_b32 s76, 0x40000000
  buffer_load_dword v120, v1, s[16:19], s76 offen
  buffer_load_dword v121, v1, s[16:19], s76 offen
  buffer_load_dword v122, v1, s[16:19], s76 offen
  buffer_load_dword v123, v1, s[16:19], s76 offen
  buffer_load_dword v124, v1, s[16:19], s76 offen
  buffer_load_dword v125, v1, s[16:19], s76 offen
  buffer_load_dword v126, v1, s[16:19], s76 offen
G_13:
  s_waitcnt lgkmcnt(6)
  s_waitcnt lgkmcnt(2)
  v_mfma_f32_32x32x16_bf16 v[64:79], v[224:227], v[48:51], v[64:79]
  ds_read_b128 v[60:63], v9 offset:4096
  s_add_u32 m0, s85, 8192
  s_nop 0
  buffer_load_dwordx4 v16, s[12:15], s79 offen lds
  s_waitcnt lgkmcnt(2)
  v_mfma_f32_32x32x16_bf16 v[80:95], v[224:227], v[52:55], v[80:95]
  ds_read_b128 v[48:51], v10 offset:0
  s_waitcnt lgkmcnt(2)
  v_mfma_f32_32x32x16_bf16 v[64:79], v[228:231], v[56:59], v[64:79]
  ds_read_b128 v[52:55], v10 offset:4096
  s_add_u32 m0, s85, 4096
  s_nop 0
  buffer_load_dwordx4 v16, s[68:71], s78 offen lds
  s_waitcnt lgkmcnt(2)
  v_mfma_f32_32x32x16_bf16 v[80:95], v[228:231], v[60:63], v[80:95]
  ds_read_b128 v[56:59], v11 offset:0
  s_waitcnt lgkmcnt(2)
  v_mfma_f32_32x32x16_bf16 v[64:79], v[232:235], v[48:51], v[64:79]
  ds_read_b128 v[60:63], v11 offset:4096
  s_add_u32 m0, s85, 12288
  s_nop 0
  buffer_load_dwordx4 v16, s[68:71], s79 offen lds
  s_waitcnt lgkmcnt(2)
  v_mfma_f32_32x32x16_bf16 v[80:95], v[232:235], v[52:55], v[80:95]
  s_waitcnt vmcnt(12)
  s_barrier
  ds_read_b128 v[240:243], v4 offset:32768
  ds_read_b128 v[244:247], v5 offset:32768
  ds_read_b128 v[248:251], v6 offset:32768
  ds_read_b128 v[252:255], v7 offset:32768
  ds_read_b128 v[48:51], v8 offset:32768
  s_waitcnt lgkmcnt(6)
  v_mfma_f32_32x32x16_bf16 v[64:79], v[236:239], v[56:59], v[64:79]
  ds_read_b128 v[52:55], v8 offset:36864
  s_add_u32 s76, s72, 2
  s_and_b32 s76, s76, 7
  s_mul_i32 s78, s76, 176128
  s_add_u32 s78, s78, s73
  s_add_u32 s78, s78, 64
  s_add_u32 s79, s78, s74
  s_add_u32 m0, s85, 32768
  s_nop 0
  buffer_load_dwordx4 v16, s[12:15], s78 offen lds
  s_waitcnt lgkmcnt(6)
  v_mfma_f32_32x32x16_bf16 v[80:95], v[236:239], v[60:63], v[80:95]
  ds_read_b128 v[56:59], v9 offset:32768
  s_waitcnt lgkmcnt(6)
  s_waitcnt lgkmcnt(2)
  v_mfma_f32_32x32x16_bf16 v[64:79], v[240:243], v[48:51], v[64:79]
  ds_read_b128 v[60:63], v9 offset:36864
  s_add_u32 m0, s85, 40960
  s_nop 0
  buffer_load_dwordx4 v16, s[12:15], s79 offen lds
  s_waitcnt lgkmcnt(2)
  v_mfma_f32_32x32x16_bf16 v[80:95], v[240:243], v[52:55], v[80:95]
  ds_read_b128 v[48:51], v10 offset:32768
  s_waitcnt lgkmcnt(2)
  v_mfma_f32_32x32x16_bf16 v[64:79], v[244:247], v[56:59], v[64:79]
  ds_read_b128 v[52:55], v10 offset:36864
  s_add_u32 m0, s85, 36864
  s_nop 0
  buffer_load_dwordx4 v16, s[68:71], s78 offen lds
  s_waitcnt lgkmcnt(2)
  v_mfma_f32_32x32x16_bf16 v[80:95], v[244:247], v[60:63], v[80:95]
  ds_read_b128 v[56:59], v11 offset:32768
  s_waitcnt lgkmcnt(2)
  v_mfma_f32_32x32x16_bf16 v[64:79], v[248:251], v[48:51], v[64:79]
  ds_read_b128 v[60:63], v11 offset:36864
  s_add_u32 m0, s85, 45056
  s_nop 0
  buffer_load_dwordx4 v16, s[68:71], s79 offen lds
  s_waitcnt lgkmcnt(2)
  v_mfma_f32_32x32x16_bf16 v[80:95], v[248:251], v[52:55], v[80:95]
  s_mov_b32 s91, 0
  s_waitcnt vmcnt(7)
  s_branch GF_19
GF_14:
  s_waitcnt vmcnt(0)
GF_19:
  s_cmp_lt_u32 s37, 2
  s_cbranch_scc0 GF_15
  s_mov_b64 s[94:95], 0
  v_cmp_ne_u32 vcc, s75, v113
  s_or_b64 s[94:95], s[94:95], vcc
  v_cmp_ne_u32 vcc, s75, v115
  s_or_b64 s[94:95], s[94:95], vcc
  v_cmp_ne_u32 vcc, s75, v117
  s_or_b64 s[94:95], s[94:95], vcc
  v_cmp_ne_u32 vcc, s75, v119
  s_or_b64 s[94:95], s[94:95], vcc
  v_cmp_ne_u32 vcc, s75, v121
  s_or_b64 s[94:95], s[94:95], vcc
  v_cmp_ne_u32 vcc, s75, v123
  s_or_b64 s[94:95], s[94:95], vcc
  v_cmp_ne_u32 vcc, s75, v125
  s_or_b64 s[94:95], s[94:95], vcc
  v_cmp_ne_u32 vcc, s75, v127
  s_or_b64 s[94:95], s[94:95], vcc
  s_cmp_eq_u64 s[94:95], 0
  s_cbranch_scc1 GF_17
  s_add_u32 s91, s91, 1
  s_cmp_gt_u32 s91, 200000
  s_cbranch_scc1 GF_17
  s_cmp_lt_u32 s37, 2
  s_cbranch_scc0 G_20
  s_lshl_b32 s76, s39, 14
  s_add_u32 s76, s76, 11010048
  s_lshl_b32 s77, s37, 9
  s_add_u32 s76, s76, s77
  v_lshlrev_b32 v3, 3, v1
  s_add_u32 s77, s76, 0
  buffer_load_dwordx2 v[112:113], v3, s[16:19], s77 offen offset:0 sc1
  s_add_u32 s77, s76, 0
  buffer_load_dwordx2 v[114:115], v3, s[16:19], s77 offen offset:2048 sc1
  s_add_u32 s77, s76, 4096
  buffer_load_dwordx2 v[116:117], v3, s[16:19], s77 offen offset:0 sc1
  s_add_u32 s77, s76, 4096
  buffer_load_dwordx2 v[118:119], v3, s[16:19], s77 offen offset:2048 sc1
  s_add_u32 s77, s76, 8192
  buffer_load_dwordx2 v[120:121], v3, s[16:19], s77 offen offset:0 sc1
  s_add_u32 s77, s76, 8192
  buffer_load_dwordx2 v[122:123], v3, s[16:19], s77 offen offset:2048 sc1
  s_add_u32 s77, s76, 12288
  buffer_load_dwordx2 v[124:125], v3, s[16:19], s77 offen offset:0 sc1
  s_add_u32 s77, s76, 12288
  buffer_load_dwordx2 v[126:127], v3, s[16:19], s77 offen offset:2048 sc1
  s_branch G_21
G_20:
  s_lshl_b32 s76, s38, 11
  s_sub_u32 s77, s37, 2
  s_lshl_b32 s77, s77, 10
  s_add_u32 s76, s76, s77
  s_add_u32 s76, s76, 10747904
  v_lshlrev_b32 v3, 4, v1
  buffer_load_dwordx4 v[112:115], v3, s[16:19], s76 offen sc1
  s_mov_b32 s76, 0x40000000
  buffer_load_dword v120, v1, s[16:19], s76 offen
  buffer_load_dword v121, v1, s[16:19], s76 offen
  buffer_load_dword v122, v1, s[16:19], s76 offen
  buffer_load_dword v123, v1, s[16:19], s76 offen
  buffer_load_dword v124, v1, s[16:19], s76 offen
  buffer_load_dword v125, v1, s[16:19], s76 offen
  buffer_load_dword v126, v1, s[16:19], s76 offen
G_21:
  s_branch GF_14
GF_17:
  v_add_f32 v112, v112, v114
  v_add_f32 v116, v116, v118
  v_add_f32 v120, v120, v122
  v_add_f32 v124, v124, v126
  v_add_f32 v112, v112, v116
  v_add_f32 v120, v120, v124
  v_add_f32 v112, v112, v120
  s_lshl_b32 s76, s37, 8
  s_add_u32 s76, s76, 131072
  v_lshlrev_b32 v3, 2, v1
  v_add_u32 v3, s76, v3
  ds_write_b32 v3, v112 offset:16384
  s_branch GF_16
GF_15:
  v_cmp_ne_u32 vcc, s75, v113
  s_mov_b64 s[94:95], vcc
  v_cmp_ne_u32 vcc, s75, v115
  s_or_b64 s[94:95], s[94:95], vcc
  s_cmp_eq_u64 s[94:95], 0
  s_cbranch_scc1 GF_18
  s_add_u32 s91, s91, 1
  s_cmp_gt_u32 s91, 200000
  s_cbranch_scc1 GF_18
  s_cmp_lt_u32 s37, 2
  s_cbranch_scc0 G_22
  s_lshl_b32 s76, s39, 14
  s_add_u32 s76, s76, 11010048
  s_lshl_b32 s77, s37, 9
  s_add_u32 s76, s76, s77
  v_lshlrev_b32 v3, 3, v1
  s_add_u32 s77, s76, 0
  buffer_load_dwordx2 v[112:113], v3, s[16:19], s77 offen offset:0 sc1
  s_add_u32 s77, s76, 0
  buffer_load_dwordx2 v[114:115], v3, s[16:19], s77 offen offset:2048 sc1
  s_add_u32 s77, s76, 4096
  buffer_load_dwordx2 v[116:117], v3, s[16:19], s77 offen offset:0 sc1
  s_add_u32 s77, s76, 4096
  buffer_load_dwordx2 v[118:119], v3, s[16:19], s77 offen offset:2048 sc1
  s_add_u32 s77, s76, 8192
  buffer_load_dwordx2 v[120:121], v3, s[16:19], s77 offen offset:0 sc1
  s_add_u32 s77, s76, 8192
  buffer_load_dwordx2 v[122:123], v3, s[16:19], s77 offen offset:2048 sc1
  s_add_u32 s77, s76, 12288
  buffer_load_dwordx2 v[124:125], v3, s[16:19], s77 offen offset:0 sc1
  s_add_u32 s77, s76, 12288
  buffer_load_dwordx2 v[126:127], v3, s[16:19], s77 offen offset:2048 sc1
  s_branch G_23
G_22:
  s_lshl_b32 s76, s38, 11
  s_sub_u32 s77, s37, 2
  s_lshl_b32 s77, s77, 10
  s_add_u32 s76, s76, s77
  s_add_u32 s76, s76, 10747904
  v_lshlrev_b32 v3, 4, v1
  buffer_load_dwordx4 v[112:115], v3, s[16:19], s76 offen sc1
  s_mov_b32 s76, 0x40000000
  buffer_load_dword v120, v1, s[16:19], s76 offen
  buffer_load_dword v121, v1, s[16:19], s76 offen
  buffer_load_dword v122, v1, s[16:19], s76 offen
  buffer_load_dword v123, v1, s[16:19], s76 offen
  buffer_load_dword v124, v1, s[16:19], s76 offen
  buffer_load_dword v125, v1, s[16:19], s76 offen
  buffer_load_dword v126, v1, s[16:19], s76 offen
G_23:
  s_branch GF_14
GF_18:
  v_rcp_f32 v114, v114
  v_sub_f32 v115, 0, v112
  s_sub_u32 s76, s37, 2
  s_lshl_b32 s76, s76, 9
  s_add_u32 s76, s76, 131072
  v_lshlrev_b32 v3, 3, v1
  v_add_u32 v3, s76, v3
  ds_write_b64 v3, v[114:115] offset:17408
  v_lshrrev_b32 v3, 1, v3
  v_add_u32 v3, 65536, v3
  ds_write_b32 v3, v114 offset:20480
GF_16:
  s_waitcnt lgkmcnt(0)
  v_mov_b32 v112, 0
  v_mov_b32 v113, 0
  v_mov_b32 v114, 0
  v_mov_b32 v115, 0
  v_mov_b32 v116, 0
  v_mov_b32 v117, 0
  v_mov_b32 v118, 0
  v_mov_b32 v119, 0
  v_mov_b32 v120, 0
  v_mov_b32 v121, 0
  v_mov_b32 v122, 0
  v_mov_b32 v123, 0
  v_mov_b32 v124, 0
  v_mov_b32 v125, 0
  v_mov_b32 v126, 0
  v_mov_b32 v127, 0
  s_waitcnt vmcnt(4)
  s_barrier
  ds_read_b64_tr_b16 v[48:49], v12 offset:0
  ds_read_b64_tr_b16 v[50:51], v12 offset:256
  v_mfma_f32_32x32x16_bf16 v[64:79], v[252:255], v[56:59], v[64:79]
  ds_read_b64_tr_b16 v[52:53], v12 offset:4096
  ds_read_b64_tr_b16 v[54:55], v12 offset:4352
  s_add_u32 s76, s72, 4
  s_and_b32 s76, s76, 7
  s_mul_i32 s78, s76, 176128
  s_add_u32 s78, s78, s73
  s_add_u32 s78, s78, 64
  s_add_u32 s79, s78, s74
  s_add_u32 m0, s85, 65536
  s_nop 0
  buffer_load_dwordx4 v16, s[12:15], s78 offen lds
  v_mfma_f32_32x32x16_bf16 v[80:95], v[252:255], v[60:63], v[80:95]
  ds_read_b64_tr_b16 v[56:57], v12 offset:1024
  ds_read_b64_tr_b16 v[58:59], v12 offset:1280
  s_waitcnt lgkmcnt(4)
  v_mfma_f32_32x32x16_bf16 v[96:111], v[48:51], v[128:131], v[96:111]
  ds_read_b64_tr_b16 v[60:61], v12 offset:5120
  ds_read_b64_tr_b16 v[62:63], v12 offset:5376
  v_and_b32 v17, 31, v1
  v_bfe_u32 v18, v17, 2, 1
  v_lshlrev_b32 v18, 4, v18
  v_lshrrev_b32 v19, 3, v17
  v_lshl_add_u32 v18, v19, 2, v18
  v_and_b32 v19, 3, v17
  v_add_u32 v18, v18, v19
  v_lshlrev_b32 v19, 5, v2
  v_add_u32 v18, v19, v18
  v_lshlrev_b32 v18, 3, v18
  v_add_u32 v18, 131072, v18
  ds_read_b64 v[40:41], v18 offset:17408
  s_waitcnt lgkmcnt(0)
  v_and_b32 v17, 31, v1
  v_lshlrev_b32 v17, 2, v17
  v_mfma_f32_32x32x16_bf16 v[112:127], v[52:55], v[128:131], v[112:127]
  ds_read_b64_tr_b16 v[48:49], v12 offset:2048
  ds_read_b64_tr_b16 v[50:51], v12 offset:2304
  v_add_u32 v17, 147456, v17
  ds_read_b32 v18, v17 offset:0
  ds_read_b32 v19, v17 offset:128
  v_cmp_gt_u32 vcc, 32, v1
  v_mov_b32 v6, 0
  v_mov_b32 v7, 0
  v_cndmask_b32 v4, 0, v41, vcc
  v_mov_b32 v10, 0
  v_lshrrev_b32 v5, 16, v4
  v_mov_b32 v11, 0
  v_or_b32 v4, v4, v5
  s_waitcnt lgkmcnt(0)
  v_cvt_pk_bf16_f32 v20, v18, v18
  v_lshlrev_b32 v20, 16, v20
  v_sub_f32 v20, v18, v20
  v_mfma_f32_32x32x16_bf16 v[96:111], v[56:59], v[132:135], v[96:111]
  ds_read_b64_tr_b16 v[52:53], v12 offset:6144
  ds_read_b64_tr_b16 v[54:55], v12 offset:6400
  s_add_u32 m0, s85, 73728
  s_nop 0
  buffer_load_dwordx4 v16, s[12:15], s79 offen lds
  v_cvt_pk_bf16_f32 v8, v18, v20
  v_and_b32 v9, 0xffff0000, v8
  v_sub_f32 v20, v20, v9
  v_cvt_pk_bf16_f32 v9, v20, v10
  s_nop 1
  v_mfma_f32_32x32x16_bf16 v[64:79], v[4:7], v[8:11], v[64:79]
  v_cvt_pk_bf16_f32 v20, v19, v19
  v_lshlrev_b32 v20, 16, v20
  v_sub_f32 v20, v19, v20
  v_cvt_pk_bf16_f32 v8, v19, v20
  v_and_b32 v9, 0xffff0000, v8
  v_sub_f32 v20, v20, v9
  v_cvt_pk_bf16_f32 v9, v20, v10
  s_nop 1
  v_mfma_f32_32x32x16_bf16 v[112:127], v[60:63], v[132:135], v[112:127]
  ds_read_b64_tr_b16 v[56:57], v12 offset:3072
  ds_read_b64_tr_b16 v[58:59], v12 offset:3328
  v_mfma_f32_32x32x16_bf16 v[80:95], v[4:7], v[8:11], v[80:95]
  s_nop 15
  s_nop 3
  v_and_b32 v17, 31, v1
  v_lshrrev_b32 v19, 5, v1
  v_lshlrev_b32 v20, 5, v2
  v_lshl_add_u32 v20, v19, 4, v20
  v_lshlrev_b32 v20, 2, v20
  v_add_u32 v20, 131072, v20
  ds_read_b128 v[4:7], v20 offset:20480
  ds_read_b128 v[8:11], v20 offset:20496
  s_waitcnt lgkmcnt(1)
  v_mul_f32 v64, v64, v4
  v_mul_f32 v80, v80, v4
  v_mul_f32 v65, v65, v5
  v_mfma_f32_32x32x16_bf16 v[96:111], v[48:51], v[136:139], v[96:111]
  ds_read_b64_tr_b16 v[60:61], v12 offset:7168
  ds_read_b64_tr_b16 v[62:63], v12 offset:7424
  v_mul_f32 v81, v81, v5
  v_mul_f32 v66, v66, v6
  v_mul_f32 v82, v82, v6
  v_mul_f32 v67, v67, v7
  v_mul_f32 v83, v83, v7
  ds_read_b128 v[4:7], v20 offset:20512
  s_waitcnt lgkmcnt(3)
  v_mul_f32 v68, v68, v8
  v_mul_f32 v84, v84, v8
  v_mul_f32 v69, v69, v9
  v_mul_f32 v85, v85, v9
  v_mul_f32 v70, v70, v10
  v_mul_f32 v86, v86, v10
  v_mul_f32 v71, v71, v11
  v_mul_f32 v87, v87, v11
  v_mfma_f32_32x32x16_bf16 v[112:127], v[52:55], v[136:139], v[112:127]
  ds_read_b64_tr_b16 v[48:49], v12 offset:16384
  ds_read_b64_tr_b16 v[50:51], v12 offset:16640
  s_add_u32 m0, s85, 69632
  s_nop 0
  buffer_load_dwordx4 v16, s[68:71], s78 offen lds
  ds_read_b128 v[8:11], v20 offset:20528
  s_waitcnt lgkmcnt(3)
  v_mul_f32 v72, v72, v4
  v_mul_f32 v88, v88, v4
  v_mul_f32 v73, v73, v5
  v_mul_f32 v89, v89, v5
  v_mul_f32 v74, v74, v6
  v_mul_f32 v90, v90, v6
  v_mul_f32 v75, v75, v7
  v_mul_f32 v91, v91, v7
  s_waitcnt lgkmcnt(0)
  v_mul_f32 v76, v76, v8
  v_mul_f32 v92, v92, v8
  v_mul_f32 v77, v77, v9
  v_mul_f32 v93, v93, v9
  v_mul_f32 v78, v78, v10
  v_mfma_f32_32x32x16_bf16 v[96:111], v[56:59], v[140:143], v[96:111]
  ds_read_b64_tr_b16 v[52:53], v12 offset:20480
  ds_read_b64_tr_b16 v[54:55], v12 offset:20736
  v_mul_f32 v94, v94, v10
  v_mul_f32 v79, v79, v11
  v_mul_f32 v95, v95, v11
  v_mov_b32 v21, v64
  v_mov_b32 v22, v80
  v_fma_f32 v24, v32, v21, v65
  v_fma_f32 v25, v32, v22, v81
  v_fma_f32 v24, -v33, v22, v24
  v_fma_f32 v25, v33, v21, v25
  v_fma_f32 v21, v32, v24, v66
  v_fma_f32 v22, v32, v25, v82
  v_fma_f32 v21, -v33, v25, v21
  v_fma_f32 v22, v33, v24, v22
  v_fma_f32 v24, v32, v21, v67
  v_mfma_f32_32x32x16_bf16 v[112:127], v[60:63], v[140:143], v[112:127]
  ds_read_b64_tr_b16 v[56:57], v12 offset:17408
  ds_read_b64_tr_b16 v[58:59], v12 offset:17664
  v_fma_f32 v25, v32, v22, v83
  v_fma_f32 v24, -v33, v22, v24
  v_fma_f32 v25, v33, v21, v25
  v_fma_f32 v21, v32, v24, v68
  v_fma_f32 v22, v32, v25, v84
  v_fma_f32 v21, -v33, v25, v21
  v_fma_f32 v22, v33, v24, v22
  v_fma_f32 v24, v32, v21, v69
  v_fma_f32 v25, v32, v22, v85
  v_fma_f32 v24, -v33, v22, v24
  v_fma_f32 v25, v33, v21, v25
  v_fma_f32 v21, v32, v24, v70
  v_fma_f32 v22, v32, v25, v86
  v_fma_f32 v21, -v33, v25, v21
  v_mfma_f32_32x32x16_bf16 v[96:111], v[48:51], v[144:147], v[96:111]
  s_cmp_eq_u32 s86, 1
  s_cbranch_scc0 CSK_24
  v_mfma_f32_32x32x16_bf16 v[128:143], v[28:31], v[48:51], 0
CSK_24:
  ds_read_b64_tr_b16 v[60:61], v12 offset:21504
  ds_read_b64_tr_b16 v[62:63], v12 offset:21760
  s_add_u32 m0, s85, 77824
  s_nop 0
  buffer_load_dwordx4 v16, s[68:71], s79 offen lds
  v_fma_f32 v22, v33, v24, v22
  v_fma_f32 v24, v32, v21, v71
  v_fma_f32 v25, v32, v22, v87
  v_fma_f32 v24, -v33, v22, v24
  v_fma_f32 v25, v33, v21, v25
  v_fma_f32 v21, v32, v24, v72
  v_fma_f32 v22, v32, v25, v88
  v_fma_f32 v21, -v33, v25, v21
  v_fma_f32 v22, v33, v24, v22
  v_fma_f32 v24, v32, v21, v73
  v_fma_f32 v25, v32, v22, v89
  v_fma_f32 v24, -v33, v22, v24
  v_fma_f32 v25, v33, v21, v25
  v_fma_f32 v21, v32, v24, v74
  s_waitcnt lgkmcnt(4)
  v_mfma_f32_32x32x16_bf16 v[112:127], v[52:55], v[144:147], v[112:127]
  s_cmp_eq_u32 s86, 2
  s_cbranch_scc0 CSK_25
  v_mfma_f32_32x32x16_bf16 v[128:143], v[28:31], v[52:55], 0
CSK_25:
  ds_read_b64_tr_b16 v[48:49], v12 offset:18432
  ds_read_b64_tr_b16 v[50:51], v12 offset:18688
  v_fma_f32 v22, v32, v25, v90
  v_fma_f32 v21, -v33, v25, v21
  v_fma_f32 v22, v33, v24, v22
  v_fma_f32 v24, v32, v21, v75
  v_fma_f32 v25, v32, v22, v91
  v_fma_f32 v24, -v33, v22, v24
  v_fma_f32 v25, v33, v21, v25
  v_fma_f32 v21, v32, v24, v76
  v_fma_f32 v22, v32, v25, v92
  v_fma_f32 v21, -v33, v25, v21
  v_fma_f32 v22, v33, v24, v22
  v_fma_f32 v24, v32, v21, v77
  v_fma_f32 v25, v32, v22, v93
  v_fma_f32 v24, -v33, v22, v24
  v_lshlrev_b32 v3, 7, v1
  s_lshl_b32 s76, s82, 14
  s_lshl_b32 s77, s37, 11
  s_add_u32 s76, s76, s77
  s_add_u32 s76, s76, 0
  s_mov_b64 s[92:93], exec
  s_mov_b64 exec, 0xffff
  buffer_load_dword v13, v3, s[24:27], s76 offen
  s_mov_b64 exec, s[92:93]
  s_waitcnt lgkmcnt(4)
  v_mfma_f32_32x32x16_bf16 v[96:111], v[56:59], v[148:151], v[96:111]
  s_cmp_eq_u32 s86, 1
  s_cbranch_scc0 CSK_26
  v_mfma_f32_32x32x16_bf16 v[128:143], v[28:31], v[56:59], v[128:143]
CSK_26:
  ds_read_b64_tr_b16 v[52:53], v12 offset:22528
  ds_read_b64_tr_b16 v[54:55], v12 offset:22784
  v_fma_f32 v25, v33, v21, v25
  v_fma_f32 v21, v32, v24, v78
  v_fma_f32 v22, v32, v25, v94
  v_fma_f32 v21, -v33, v25, v21
  v_fma_f32 v22, v33, v24, v22
  v_fma_f32 v24, v32, v21, v79
  v_fma_f32 v25, v32, v22, v95
  v_fma_f32 v24, -v33, v22, v24
  v_fma_f32 v25, v33, v21, v25
  v_lshlrev_b32 v18, 1, v2
  v_add_u32 v18, v18, v19
  v_lshlrev_b32 v18, 8, v18
  v_lshl_add_u32 v18, v17, 3, v18
  v_add_u32 v18, 131072, v18
  s_waitcnt lgkmcnt(4)
  v_mfma_f32_32x32x16_bf16 v[112:127], v[60:63], v[148:151], v[112:127]
  s_cmp_eq_u32 s86, 2
  s_cbranch_scc0 CSK_27
  v_mfma_f32_32x32x16_bf16 v[128:143], v[28:31], v[60:63], v[128:143]
CSK_27:
  ds_read_b64_tr_b16 v[56:57], v12 offset:19456
  ds_read_b64_tr_b16 v[58:59], v12 offset:19712
  ds_write_b64 v18, v[24:25] offset:18432
  s_waitcnt lgkmcnt(5)
  v_mfma_f32_32x32x16_bf16 v[96:111], v[48:51], v[152:155], v[96:111]
  s_cmp_eq_u32 s86, 1
  s_cbranch_scc0 CSK_28
  v_mfma_f32_32x32x16_bf16 v[128:143], v[28:31], v[48:51], v[128:143]
CSK_28:
  ds_read_b64_tr_b16 v[60:61], v12 offset:23552
  ds_read_b64_tr_b16 v[62:63], v12 offset:23808
  s_waitcnt lgkmcnt(5)
  v_mfma_f32_32x32x16_bf16 v[112:127], v[52:55], v[152:155], v[112:127]
  s_cmp_eq_u32 s86, 2
  s_cbranch_scc0 CSK_29
  v_mfma_f32_32x32x16_bf16 v[128:143], v[28:31], v[52:55], v[128:143]
CSK_29:
  s_waitcnt vmcnt(5)
  s_barrier
  s_waitcnt lgkmcnt(0)
  v_and_b32 v17, 31, v1
  v_lshlrev_b32 v18, 3, v17
  v_add_u32 v18, 131072, v18
  ds_read_b64 v[4:5], v18 offset:18432
  ds_read_b64 v[6:7], v18 offset:18688
  ds_read_b64 v[8:9], v18 offset:18944
  ds_read_b64 v[10:11], v18 offset:19200
  s_waitcnt lgkmcnt(0)
  v_fma_f32 v19, v36, v4, v6
  v_fma_f32 v20, v36, v5, v7
  v_fma_f32 v19, -v37, v5, v19
  v_fma_f32 v5, v37, v4, v20
  v_mov_b32 v4, v19
  v_fma_f32 v19, v36, v4, v8
  v_fma_f32 v20, v36, v5, v9
  v_fma_f32 v19, -v37, v5, v19
  v_fma_f32 v5, v37, v4, v20
  v_mov_b32 v4, v19
  v_fma_f32 v19, v36, v4, v10
  v_fma_f32 v20, v36, v5, v11
  v_fma_f32 v19, -v37, v5, v19
  v_fma_f32 v5, v37, v4, v20
  v_mov_b32 v4, v19
  ds_read_b64 v[6:7], v18 offset:19456
  ds_read_b64 v[8:9], v18 offset:19712
  ds_read_b64 v[10:11], v18 offset:19968
  ds_read_b64 v[22:23], v18 offset:20224
  s_waitcnt lgkmcnt(0)
  v_fma_f32 v19, v36, v4, v6
  v_fma_f32 v20, v36, v5, v7
  v_fma_f32 v19, -v37, v5, v19
  v_fma_f32 v5, v37, v4, v20
  v_mov_b32 v4, v19
  v_fma_f32 v19, v36, v4, v8
  v_fma_f32 v20, v36, v5, v9
  v_fma_f32 v19, -v37, v5, v19
  v_fma_f32 v5, v37, v4, v20
  v_mov_b32 v4, v19
  v_fma_f32 v19, v36, v4, v10
  v_fma_f32 v20, v36, v5, v11
  v_fma_f32 v19, -v37, v5, v19
  v_fma_f32 v5, v37, v4, v20
  v_mov_b32 v4, v19
  v_fma_f32 v19, v36, v4, v22
  v_fma_f32 v20, v36, v5, v23
  v_fma_f32 v19, -v37, v5, v19
  v_fma_f32 v5, v37, v4, v20
  v_mov_b32 v4, v19
  v_mov_b32 v6, v5
  v_mov_b32 v5, s75
  v_mov_b32 v7, s75
  s_lshl_b32 s76, s39, 5
  v_add_u32 v17, s76, v17
  v_lshlrev_b32 v17, 4, v17
  s_lshl_b32 s76, s38, 13
  s_add_u32 s76, s76, 10485760
  v_cmp_gt_u32 vcc, 32, v1
  s_and_saveexec_b64 s[92:93], vcc
  buffer_store_dwordx4 v[4:7], v17, s[16:19], s76 offen sc1
  s_mov_b64 exec, s[92:93]
  ds_read_b64_tr_b16 v[48:49], v12 offset:32768
  ds_read_b64_tr_b16 v[50:51], v12 offset:33024
  v_mfma_f32_32x32x16_bf16 v[96:111], v[56:59], v[156:159], v[96:111]
  s_cmp_eq_u32 s86, 1
  s_cbranch_scc0 CSK_30
  v_mfma_f32_32x32x16_bf16 v[128:143], v[28:31], v[56:59], v[128:143]
CSK_30:
  ds_read_b64_tr_b16 v[52:53], v12 offset:36864
  ds_read_b64_tr_b16 v[54:55], v12 offset:37120
  s_add_u32 s76, s72, 6
  s_and_b32 s76, s76, 7
  s_mul_i32 s78, s76, 176128
  s_add_u32 s78, s78, s73
  s_add_u32 s78, s78, 64
  s_add_u32 s79, s78, s74
  s_add_u32 m0, s85, 98304
  s_nop 0
  buffer_load_dwordx4 v16, s[12:15], s78 offen lds
  v_mfma_f32_32x32x16_bf16 v[112:127], v[60:63], v[156:159], v[112:127]
  s_cmp_eq_u32 s86, 2
  s_cbranch_scc0 CSK_31
  v_mfma_f32_32x32x16_bf16 v[128:143], v[28:31], v[60:63], v[128:143]
CSK_31:
  ds_read_b64_tr_b16 v[56:57], v12 offset:33792
  ds_read_b64_tr_b16 v[58:59], v12 offset:34048
  s_nop 7
  s_nop 7
  s_add_u32 s77, s72, 1
  s_and_b32 s77, s77, 7
  s_lshl_b32 s76, s39, 3
  s_add_u32 s76, s76, s77
  s_lshl_b32 s76, s76, 11
  s_sub_u32 s77, s86, 1
  s_lshl_b32 s77, s77, 8
  s_add_u32 s76, s76, s77
  s_add_u32 s76, s76, 11011072
  s_lshl_b32 s77, s2, 11
  s_add_u32 s77, s77, 11665408
  s_cmp_eq_u32 s86, 0
  s_cselect_b32 s76, s77, s76
  v_mov_b32 v129, s75
  v_lshlrev_b32 v130, 3, v1
  s_mov_b64 s[92:93], exec
  s_mov_b64 exec, 0xffffffff
  buffer_store_dwordx2 v[128:129], v130, s[16:19], s76 offen sc1
  s_mov_b64 exec, s[92:93]
  s_waitcnt lgkmcnt(4)
  v_mfma_f32_32x32x16_bf16 v[96:111], v[48:51], v[160:163], v[96:111]
  ds_read_b64_tr_b16 v[60:61], v12 offset:37888
  ds_read_b64_tr_b16 v[62:63], v12 offset:38144
  s_waitcnt lgkmcnt(4)
  v_mfma_f32_32x32x16_bf16 v[112:127], v[52:55], v[160:163], v[112:127]
  ds_read_b64_tr_b16 v[48:49], v12 offset:34816
  ds_read_b64_tr_b16 v[50:51], v12 offset:35072
  s_add_u32 m0, s85, 106496
  s_nop 0
  buffer_load_dwordx4 v16, s[12:15], s79 offen lds
  s_waitcnt lgkmcnt(4)
  v_mfma_f32_32x32x16_bf16 v[96:111], v[56:59], v[164:167], v[96:111]
  ds_read_b64_tr_b16 v[52:53], v12 offset:38912
  ds_read_b64_tr_b16 v[54:55], v12 offset:39168
  s_waitcnt lgkmcnt(4)
  v_mfma_f32_32x32x16_bf16 v[112:127], v[60:63], v[164:167], v[112:127]
  ds_read_b64_tr_b16 v[56:57], v12 offset:35840
  ds_read_b64_tr_b16 v[58:59], v12 offset:36096
  s_waitcnt lgkmcnt(4)
  v_mfma_f32_32x32x16_bf16 v[96:111], v[48:51], v[168:171], v[96:111]
  ds_read_b64_tr_b16 v[60:61], v12 offset:39936
  ds_read_b64_tr_b16 v[62:63], v12 offset:40192
  s_add_u32 m0, s85, 102400
  s_nop 0
  buffer_load_dwordx4 v16, s[68:71], s78 offen lds
  s_waitcnt lgkmcnt(4)
  v_mfma_f32_32x32x16_bf16 v[112:127], v[52:55], v[168:171], v[112:127]
  ds_read_b64_tr_b16 v[48:49], v12 offset:49152
  ds_read_b64_tr_b16 v[50:51], v12 offset:49408
  s_waitcnt lgkmcnt(4)
  v_mfma_f32_32x32x16_bf16 v[96:111], v[56:59], v[172:175], v[96:111]
  ds_read_b64_tr_b16 v[52:53], v12 offset:53248
  ds_read_b64_tr_b16 v[54:55], v12 offset:53504
  s_waitcnt lgkmcnt(4)
  v_mfma_f32_32x32x16_bf16 v[112:127], v[60:63], v[172:175], v[112:127]
  ds_read_b64_tr_b16 v[56:57], v12 offset:50176
  ds_read_b64_tr_b16 v[58:59], v12 offset:50432
  s_add_u32 m0, s85, 110592
  s_nop 0
  buffer_load_dwordx4 v16, s[68:71], s79 offen lds
  s_waitcnt lgkmcnt(4)
  v_mfma_f32_32x32x16_bf16 v[96:111], v[48:51], v[176:179], v[96:111]
  ds_read_b64_tr_b16 v[60:61], v12 offset:54272
  ds_read_b64_tr_b16 v[62:63], v12 offset:54528
  s_waitcnt lgkmcnt(4)
  v_mfma_f32_32x32x16_bf16 v[112:127], v[52:55], v[176:179], v[112:127]
  ds_read_b64_tr_b16 v[48:49], v12 offset:51200
  ds_read_b64_tr_b16 v[50:51], v12 offset:51456
  v_lshlrev_b32 v3, 7, v1
  s_lshl_b32 s76, s82, 14
  s_lshl_b32 s77, s37, 11
  s_add_u32 s76, s76, s77
  s_add_u32 s76, s76, 8192
  s_mov_b64 s[92:93], exec
  s_mov_b64 exec, 0xffff
  buffer_load_dword v13, v3, s[24:27], s76 offen
  s_mov_b64 exec, s[92:93]
  s_waitcnt lgkmcnt(4)
  v_mfma_f32_32x32x16_bf16 v[96:111], v[56:59], v[180:183], v[96:111]
  ds_read_b64_tr_b16 v[52:53], v12 offset:55296
  ds_read_b64_tr_b16 v[54:55], v12 offset:55552
  s_waitcnt lgkmcnt(4)
  v_mfma_f32_32x32x16_bf16 v[112:127], v[60:63], v[180:183], v[112:127]
  ds_read_b64_tr_b16 v[56:57], v12 offset:52224
  ds_read_b64_tr_b16 v[58:59], v12 offset:52480
  s_waitcnt lgkmcnt(4)
  v_mfma_f32_32x32x16_bf16 v[96:111], v[48:51], v[184:187], v[96:111]
  ds_read_b64_tr_b16 v[60:61], v12 offset:56320
  ds_read_b64_tr_b16 v[62:63], v12 offset:56576
  s_waitcnt lgkmcnt(4)
  v_mfma_f32_32x32x16_bf16 v[112:127], v[52:55], v[184:187], v[112:127]
  s_waitcnt vmcnt(8)
  s_barrier
  v_xor_b32 v12, 0x10000, v12
  ds_read_b64_tr_b16 v[48:49], v12 offset:0
  ds_read_b64_tr_b16 v[50:51], v12 offset:256
  s_add_u32 s77, s98, 0
  s_add_u32 m0, s89, 0
  s_nop 0
  buffer_load_dwordx4 v43, s[20:23], s77 offen lds
  s_waitcnt lgkmcnt(4)
  v_mfma_f32_32x32x16_bf16 v[96:111], v[56:59], v[188:191], v[96:111]
  ds_read_b64_tr_b16 v[52:53], v12 offset:4096
  ds_read_b64_tr_b16 v[54:55], v12 offset:4352
  s_waitcnt lgkmcnt(4)
  v_mfma_f32_32x32x16_bf16 v[112:127], v[60:63], v[188:191], v[112:127]
  ds_read_b64_tr_b16 v[56:57], v12 offset:1024
  ds_read_b64_tr_b16 v[58:59], v12 offset:1280
  s_waitcnt lgkmcnt(4)
  v_mfma_f32_32x32x16_bf16 v[96:111], v[48:51], v[192:195], v[96:111]
  ds_read_b64_tr_b16 v[60:61], v12 offset:5120
  ds_read_b64_tr_b16 v[62:63], v12 offset:5376
  s_add_u32 s77, s98, 8192
  s_add_u32 m0, s89, 1024
  s_nop 0
  buffer_load_dwordx4 v43, s[20:23], s77 offen lds
  s_waitcnt lgkmcnt(4)
  v_mfma_f32_32x32x16_bf16 v[112:127], v[52:55], v[192:195], v[112:127]
  ds_read_b64_tr_b16 v[48:49], v12 offset:2048
  ds_read_b64_tr_b16 v[50:51], v12 offset:2304
  s_waitcnt lgkmcnt(4)
  v_mfma_f32_32x32x16_bf16 v[96:111], v[56:59], v[196:199], v[96:111]
  ds_read_b64_tr_b16 v[52:53], v12 offset:6144
  ds_read_b64_tr_b16 v[54:55], v12 offset:6400
  s_waitcnt lgkmcnt(4)
  v_mfma_f32_32x32x16_bf16 v[112:127], v[60:63], v[196:199], v[112:127]
  ds_read_b64_tr_b16 v[56:57], v12 offset:3072
  ds_read_b64_tr_b16 v[58:59], v12 offset:3328
  s_add_u32 s77, s98, 393216
  s_add_u32 m0, s89, 16384
  s_nop 0
  buffer_load_dwordx4 v43, s[20:23], s77 offen lds
  s_waitcnt lgkmcnt(4)
  v_mfma_f32_32x32x16_bf16 v[96:111], v[48:51], v[200:203], v[96:111]
  ds_read_b64_tr_b16 v[60:61], v12 offset:7168
  ds_read_b64_tr_b16 v[62:63], v12 offset:7424
  s_waitcnt lgkmcnt(4)
  v_mfma_f32_32x32x16_bf16 v[112:127], v[52:55], v[200:203], v[112:127]
  ds_read_b64_tr_b16 v[48:49], v12 offset:16384
  ds_read_b64_tr_b16 v[50:51], v12 offset:16640
  s_waitcnt lgkmcnt(4)
  v_mfma_f32_32x32x16_bf16 v[96:111], v[56:59], v[204:207], v[96:111]
  ds_read_b64_tr_b16 v[52:53], v12 offset:20480
  ds_read_b64_tr_b16 v[54:55], v12 offset:20736
  s_add_u32 s77, s98, 401408
  s_add_u32 m0, s89, 17408
  s_nop 0
  buffer_load_dwordx4 v43, s[20:23], s77 offen lds
  s_waitcnt lgkmcnt(4)
  v_mfma_f32_32x32x16_bf16 v[112:127], v[60:63], v[204:207], v[112:127]
  ds_read_b64_tr_b16 v[56:57], v12 offset:17408
  ds_read_b64_tr_b16 v[58:59], v12 offset:17664
  s_waitcnt lgkmcnt(4)
  v_mfma_f32_32x32x16_bf16 v[96:111], v[48:51], v[208:211], v[96:111]
  ds_read_b64_tr_b16 v[60:61], v12 offset:21504
  ds_read_b64_tr_b16 v[62:63], v12 offset:21760
  s_waitcnt lgkmcnt(4)
  v_mfma_f32_32x32x16_bf16 v[112:127], v[52:55], v[208:211], v[112:127]
  ds_read_b64_tr_b16 v[48:49], v12 offset:18432
  ds_read_b64_tr_b16 v[50:51], v12 offset:18688
  s_waitcnt lgkmcnt(4)
  v_mfma_f32_32x32x16_bf16 v[96:111], v[56:59], v[212:215], v[96:111]
  ds_read_b64_tr_b16 v[52:53], v12 offset:22528
  ds_read_b64_tr_b16 v[54:55], v12 offset:22784
  s_waitcnt lgkmcnt(4)
  v_mfma_f32_32x32x16_bf16 v[112:127], v[60:63], v[212:215], v[112:127]
  ds_read_b64_tr_b16 v[56:57], v12 offset:19456
  ds_read_b64_tr_b16 v[58:59], v12 offset:19712
  s_waitcnt lgkmcnt(4)
  v_mfma_f32_32x32x16_bf16 v[96:111], v[48:51], v[216:219], v[96:111]
  ds_read_b64_tr_b16 v[60:61], v12 offset:23552
  ds_read_b64_tr_b16 v[62:63], v12 offset:23808
  s_waitcnt lgkmcnt(4)
  v_mfma_f32_32x32x16_bf16 v[112:127], v[52:55], v[216:219], v[112:127]
  s_waitcnt vmcnt(5)
  s_barrier
  ds_read_b64_tr_b16 v[48:49], v12 offset:32768
  ds_read_b64_tr_b16 v[50:51], v12 offset:33024
  s_waitcnt lgkmcnt(4)
  v_mfma_f32_32x32x16_bf16 v[96:111], v[56:59], v[220:223], v[96:111]
  ds_read_b64_tr_b16 v[52:53], v12 offset:36864
  ds_read_b64_tr_b16 v[54:55], v12 offset:37120
  s_waitcnt lgkmcnt(4)
  v_mfma_f32_32x32x16_bf16 v[112:127], v[60:63], v[220:223], v[112:127]
  ds_read_b64_tr_b16 v[56:57], v12 offset:33792
  ds_read_b64_tr_b16 v[58:59], v12 offset:34048
  s_add_u32 s77, s98, 786432
  s_add_u32 m0, s89, 32768
  s_nop 0
  buffer_load_dwordx4 v43, s[20:23], s77 offen lds
  v_and_b32 v26, 31, v1
  s_lshl_b32 s76, s39, 5
  v_add_u32 v26, s76, v26
  v_lshlrev_b32 v26, 4, v26
  v_lshrrev_b32 v3, 5, v1
  s_sub_u32 s76, s38, 1
  v_sub_u32 v3, s76, v3
  v_lshlrev_b32 v3, 13, v3
  v_add_u32 v3, v3, v26
  s_mov_b32 s76, 10485760
  v_mov_b32 v27, 0x7ff00000
  v_subrev_u32 v26, 0, v3
  v_cmp_gt_i32 vcc, 0, v26
  s_nop 1
  v_cndmask_b32 v26, v26, v27, vcc
  buffer_load_dwordx4 v[160:163], v26, s[16:19], s76 offen sc1
  v_subrev_u32 v26, 16384, v3
  v_cmp_gt_i32 vcc, 0, v26
  s_nop 1
  v_cndmask_b32 v26, v26, v27, vcc
  buffer_load_dwordx4 v[164:167], v26, s[16:19], s76 offen sc1
  v_subrev_u32 v26, 32768, v3
  v_cmp_gt_i32 vcc, 0, v26
  s_nop 1
  v_cndmask_b32 v26, v26, v27, vcc
  buffer_load_dwordx4 v[168:171], v26, s[16:19], s76 offen sc1
  v_subrev_u32 v26, 49152, v3
  v_cmp_gt_i32 vcc, 0, v26
  s_nop 1
  v_cndmask_b32 v26, v26, v27, vcc
  buffer_load_dwordx4 v[172:175], v26, s[16:19], s76 offen sc1
  v_subrev_u32 v26, 65536, v3
  v_cmp_gt_i32 vcc, 0, v26
  s_nop 1
  v_cndmask_b32 v26, v26, v27, vcc
  buffer_load_dwordx4 v[176:179], v26, s[16:19], s76 offen sc1
  v_subrev_u32 v26, 81920, v3
  v_cmp_gt_i32 vcc, 0, v26
  s_nop 1
  v_cndmask_b32 v26, v26, v27, vcc
  buffer_load_dwordx4 v[180:183], v26, s[16:19], s76 offen sc1
  v_subrev_u32 v26, 98304, v3
  v_cmp_gt_i32 vcc, 0, v26
  s_nop 1
  v_cndmask_b32 v26, v26, v27, vcc
  buffer_load_dwordx4 v[184:187], v26, s[16:19], s76 offen sc1
  v_subrev_u32 v26, 114688, v3
  v_cmp_gt_i32 vcc, 0, v26
  s_nop 1
  v_cndmask_b32 v26, v26, v27, vcc
  buffer_load_dwordx4 v[188:191], v26, s[16:19], s76 offen sc1
  s_lshl_b32 s81, s39, 12
  s_add_u32 s84, s101, s81
  s_add_u32 s84, s84, 88064
  s_waitcnt lgkmcnt(4)
  v_mfma_f32_32x32x16_bf16 v[96:111], v[48:51], v[224:227], v[96:111]
  ds_read_b64_tr_b16 v[60:61], v12 offset:37888
  ds_read_b64_tr_b16 v[62:63], v12 offset:38144
  s_waitcnt lgkmcnt(4)
  v_mfma_f32_32x32x16_bf16 v[112:127], v[52:55], v[224:227], v[112:127]
  ds_read_b64_tr_b16 v[48:49], v12 offset:34816
  ds_read_b64_tr_b16 v[50:51], v12 offset:35072
  s_waitcnt lgkmcnt(4)
  v_mfma_f32_32x32x16_bf16 v[96:111], v[56:59], v[228:231], v[96:111]
  ds_read_b64_tr_b16 v[52:53], v12 offset:38912
  ds_read_b64_tr_b16 v[54:55], v12 offset:39168
  s_add_u32 s77, s98, 794624
  s_add_u32 m0, s89, 33792
  s_nop 0
  buffer_load_dwordx4 v43, s[20:23], s77 offen lds
  s_waitcnt lgkmcnt(4)
  v_mfma_f32_32x32x16_bf16 v[112:127], v[60:63], v[228:231], v[112:127]
  ds_read_b64_tr_b16 v[56:57], v12 offset:35840
  ds_read_b64_tr_b16 v[58:59], v12 offset:36096
  s_waitcnt lgkmcnt(4)
  v_mfma_f32_32x32x16_bf16 v[96:111], v[48:51], v[232:235], v[96:111]
  ds_read_b64_tr_b16 v[60:61], v12 offset:39936
  ds_read_b64_tr_b16 v[62:63], v12 offset:40192
  s_waitcnt lgkmcnt(4)
  v_mfma_f32_32x32x16_bf16 v[112:127], v[52:55], v[232:235], v[112:127]
  ds_read_b64_tr_b16 v[48:49], v12 offset:49152
  ds_read_b64_tr_b16 v[50:51], v12 offset:49408
  s_add_u32 s77, s99, 1146880
  s_add_u32 m0, s89, 49152
  s_nop 0
  buffer_load_dwordx4 v43, s[20:23], s77 offen lds
  s_waitcnt lgkmcnt(4)
  v_mfma_f32_32x32x16_bf16 v[96:111], v[56:59], v[236:239], v[96:111]
  ds_read_b64_tr_b16 v[52:53], v12 offset:53248
  ds_read_b64_tr_b16 v[54:55], v12 offset:53504
  s_waitcnt lgkmcnt(4)
  v_mfma_f32_32x32x16_bf16 v[112:127], v[60:63], v[236:239], v[112:127]
  ds_read_b64_tr_b16 v[56:57], v12 offset:50176
  ds_read_b64_tr_b16 v[58:59], v12 offset:50432
  s_waitcnt lgkmcnt(4)
  v_mfma_f32_32x32x16_bf16 v[96:111], v[48:51], v[240:243], v[96:111]
  ds_read_b64_tr_b16 v[60:61], v12 offset:54272
  ds_read_b64_tr_b16 v[62:63], v12 offset:54528
  s_add_u32 s77, s99, 1155072
  s_add_u32 m0, s89, 50176
  s_nop 0
  buffer_load_dwordx4 v43, s[20:23], s77 offen lds
  s_waitcnt lgkmcnt(4)
  v_mfma_f32_32x32x16_bf16 v[112:127], v[52:55], v[240:243], v[112:127]
  ds_read_b64_tr_b16 v[48:49], v12 offset:51200
  ds_read_b64_tr_b16 v[50:51], v12 offset:51456
  s_waitcnt lgkmcnt(4)
  v_mfma_f32_32x32x16_bf16 v[96:111], v[56:59], v[244:247], v[96:111]
  ds_read_b64_tr_b16 v[52:53], v12 offset:55296
  ds_read_b64_tr_b16 v[54:55], v12 offset:55552
  s_waitcnt lgkmcnt(4)
  v_mfma_f32_32x32x16_bf16 v[112:127], v[60:63], v[244:247], v[112:127]
  ds_read_b64_tr_b16 v[56:57], v12 offset:52224
  ds_read_b64_tr_b16 v[58:59], v12 offset:52480
  s_waitcnt lgkmcnt(4)
  v_mfma_f32_32x32x16_bf16 v[96:111], v[48:51], v[248:251], v[96:111]
  ds_read_b64_tr_b16 v[60:61], v12 offset:56320
  ds_read_b64_tr_b16 v[62:63], v12 offset:56576
  s_waitcnt lgkmcnt(4)
  v_mfma_f32_32x32x16_bf16 v[112:127], v[52:55], v[248:251], v[112:127]
  s_waitcnt lgkmcnt(2)
  v_mfma_f32_32x32x16_bf16 v[96:111], v[56:59], v[252:255], v[96:111]
  s_waitcnt lgkmcnt(0)
  v_mfma_f32_32x32x16_bf16 v[112:127], v[60:63], v[252:255], v[112:127]
  v_and_b32 v25, 31, v1
  v_lshlrev_b32 v17, 3, v25
  v_add_u32 v17, 131072, v17
  ds_read_b64 v[192:193], v17 offset:18432
  ds_read_b64 v[194:195], v17 offset:18688
  ds_read_b64 v[196:197], v17 offset:18944
  ds_read_b64 v[198:199], v17 offset:19200
  ds_read_b64 v[200:201], v17 offset:19456
  ds_read_b64 v[202:203], v17 offset:19712
  ds_read_b64 v[204:205], v17 offset:19968
  ds_read_b64 v[206:207], v17 offset:20224
  v_mul_f32 v22, v39, v39
  v_mul_f32 v23, v38, v39
  v_fma_f32 v22, v38, v38, -v22
  v_add_f32 v23, v23, v23
  s_mov_b32 s91, 0
  s_waitcnt vmcnt(3)
LB_32:
  v_lshrrev_b32 v18, 5, v1
  s_sub_u32 s76, s38, 1
  v_sub_u32 v18, s76, v18
  s_mov_b64 s[94:95], 0
  v_cmp_ne_u32 vcc, s75, v161
  v_cmp_ne_u32 s[92:93], s75, v163
  s_or_b64 s[92:93], s[92:93], vcc
  v_cmp_le_i32 vcc, 0, v18
  s_and_b64 s[92:93], s[92:93], vcc
  s_or_b64 s[94:95], s[94:95], s[92:93]
  v_cmp_ne_u32 vcc, s75, v165
  v_cmp_ne_u32 s[92:93], s75, v167
  s_or_b64 s[92:93], s[92:93], vcc
  v_cmp_le_i32 vcc, 2, v18
  s_and_b64 s[92:93], s[92:93], vcc
  s_or_b64 s[94:95], s[94:95], s[92:93]
  v_cmp_ne_u32 vcc, s75, v169
  v_cmp_ne_u32 s[92:93], s75, v171
  s_or_b64 s[92:93], s[92:93], vcc
  v_cmp_le_i32 vcc, 4, v18
  s_and_b64 s[92:93], s[92:93], vcc
  s_or_b64 s[94:95], s[94:95], s[92:93]
  v_cmp_ne_u32 vcc, s75, v173
  v_cmp_ne_u32 s[92:93], s75, v175
  s_or_b64 s[92:93], s[92:93], vcc
  v_cmp_le_i32 vcc, 6, v18
  s_and_b64 s[92:93], s[92:93], vcc
  s_or_b64 s[94:95], s[94:95], s[92:93]
  v_cmp_ne_u32 vcc, s75, v177
  v_cmp_ne_u32 s[92:93], s75, v179
  s_or_b64 s[92:93], s[92:93], vcc
  v_cmp_le_i32 vcc, 8, v18
  s_and_b64 s[92:93], s[92:93], vcc
  s_or_b64 s[94:95], s[94:95], s[92:93]
  v_cmp_ne_u32 vcc, s75, v181
  v_cmp_ne_u32 s[92:93], s75, v183
  s_or_b64 s[92:93], s[92:93], vcc
  v_cmp_le_i32 vcc, 10, v18
  s_and_b64 s[92:93], s[92:93], vcc
  s_or_b64 s[94:95], s[94:95], s[92:93]
  v_cmp_ne_u32 vcc, s75, v185
  v_cmp_ne_u32 s[92:93], s75, v187
  s_or_b64 s[92:93], s[92:93], vcc
  v_cmp_le_i32 vcc, 12, v18
  s_and_b64 s[92:93], s[92:93], vcc
  s_or_b64 s[94:95], s[94:95], s[92:93]
  v_cmp_ne_u32 vcc, s75, v189
  v_cmp_ne_u32 s[92:93], s75, v191
  s_or_b64 s[92:93], s[92:93], vcc
  v_cmp_le_i32 vcc, 14, v18
  s_and_b64 s[92:93], s[92:93], vcc
  s_or_b64 s[94:95], s[94:95], s[92:93]
  s_cmp_eq_u64 s[94:95], 0
  s_cbranch_scc1 LBG_33
  s_add_u32 s91, s91, 1
  s_cmp_gt_u32 s91, 200000
  s_cbranch_scc1 LBG_33
  v_and_b32 v26, 31, v1
  s_lshl_b32 s76, s39, 5
  v_add_u32 v26, s76, v26
  v_lshlrev_b32 v26, 4, v26
  v_lshrrev_b32 v3, 5, v1
  s_sub_u32 s76, s38, 1
  v_sub_u32 v3, s76, v3
  v_lshlrev_b32 v3, 13, v3
  v_add_u32 v3, v3, v26
  s_mov_b32 s76, 10485760
  v_mov_b32 v27, 0x7ff00000
  v_subrev_u32 v26, 0, v3
  v_cmp_gt_i32 vcc, 0, v26
  s_nop 1
  v_cndmask_b32 v26, v26, v27, vcc
  buffer_load_dwordx4 v[160:163], v26, s[16:19], s76 offen sc1
  v_subrev_u32 v26, 16384, v3
  v_cmp_gt_i32 vcc, 0, v26
  s_nop 1
  v_cndmask_b32 v26, v26, v27, vcc
  buffer_load_dwordx4 v[164:167], v26, s[16:19], s76 offen sc1
  v_subrev_u32 v26, 32768, v3
  v_cmp_gt_i32 vcc, 0, v26
  s_nop 1
  v_cndmask_b32 v26, v26, v27, vcc
  buffer_load_dwordx4 v[168:171], v26, s[16:19], s76 offen sc1
  v_subrev_u32 v26, 49152, v3
  v_cmp_gt_i32 vcc, 0, v26
  s_nop 1
  v_cndmask_b32 v26, v26, v27, vcc
  buffer_load_dwordx4 v[172:175], v26, s[16:19], s76 offen sc1
  v_subrev_u32 v26, 65536, v3
  v_cmp_gt_i32 vcc, 0, v26
  s_nop 1
  v_cndmask_b32 v26, v26, v27, vcc
  buffer_load_dwordx4 v[176:179], v26, s[16:19], s76 offen sc1
  v_subrev_u32 v26, 81920, v3
  v_cmp_gt_i32 vcc, 0, v26
  s_nop 1
  v_cndmask_b32 v26, v26, v27, vcc
  buffer_load_dwordx4 v[180:183], v26, s[16:19], s76 offen sc1
  v_subrev_u32 v26, 98304, v3
  v_cmp_gt_i32 vcc, 0, v26
  s_nop 1
  v_cndmask_b32 v26, v26, v27, vcc
  buffer_load_dwordx4 v[184:187], v26, s[16:19], s76 offen sc1
  v_subrev_u32 v26, 114688, v3
  v_cmp_gt_i32 vcc, 0, v26
  s_nop 1
  v_cndmask_b32 v26, v26, v27, vcc
  buffer_load_dwordx4 v[188:191], v26, s[16:19], s76 offen sc1
  s_waitcnt vmcnt(0)
  s_branch LB_32
LBG_33:
  v_mov_b32 v18, v188
  v_mov_b32 v19, v190
  v_fma_f32 v20, v22, v18, v184
  v_fma_f32 v21, v22, v19, v186
  v_fma_f32 v20, -v23, v19, v20
  v_fma_f32 v19, v23, v18, v21
  v_mov_b32 v18, v20
  v_fma_f32 v20, v22, v18, v180
  v_fma_f32 v21, v22, v19, v182
  v_fma_f32 v20, -v23, v19, v20
  v_fma_f32 v19, v23, v18, v21
  v_mov_b32 v18, v20
  v_fma_f32 v20, v22, v18, v176
  v_fma_f32 v21, v22, v19, v178
  v_fma_f32 v20, -v23, v19, v20
  v_fma_f32 v19, v23, v18, v21
  v_mov_b32 v18, v20
  v_fma_f32 v20, v22, v18, v172
  v_fma_f32 v21, v22, v19, v174
  v_fma_f32 v20, -v23, v19, v20
  v_fma_f32 v19, v23, v18, v21
  v_mov_b32 v18, v20
  v_fma_f32 v20, v22, v18, v168
  v_fma_f32 v21, v22, v19, v170
  v_fma_f32 v20, -v23, v19, v20
  v_fma_f32 v19, v23, v18, v21
  v_mov_b32 v18, v20
  v_fma_f32 v20, v22, v18, v164
  v_fma_f32 v21, v22, v19, v166
  v_fma_f32 v20, -v23, v19, v20
  v_fma_f32 v19, v23, v18, v21
  v_mov_b32 v18, v20
  v_fma_f32 v20, v22, v18, v160
  v_fma_f32 v21, v22, v19, v162
  v_fma_f32 v20, -v23, v19, v20
  v_fma_f32 v19, v23, v18, v21
  v_mov_b32 v18, v20
  v_mov_b32 v20, v18
  v_mov_b32 v21, v19
  s_nop 1
  v_permlane32_swap_b32 v18, v20
  v_permlane32_swap_b32 v19, v21
  s_nop 1
  v_fma_f32 v18, v38, v20, v18
  v_fma_f32 v19, v38, v21, v19
  v_fma_f32 v18, -v39, v21, v18
  v_fma_f32 v19, v39, v20, v19
  v_lshrrev_b32 v22, 5, v1
  v_lshl_add_u32 v22, v2, 1, v22
  s_waitcnt lgkmcnt(0)
  v_fma_f32 v20, v36, v18, v192
  v_fma_f32 v21, v36, v19, v193
  v_cmp_lt_u32 vcc, 0, v22
  v_fma_f32 v20, -v37, v19, v20
  v_fma_f32 v21, v37, v18, v21
  v_cndmask_b32 v18, v18, v20, vcc
  v_cndmask_b32 v19, v19, v21, vcc
  v_fma_f32 v20, v36, v18, v194
  v_fma_f32 v21, v36, v19, v195
  v_cmp_lt_u32 vcc, 1, v22
  v_fma_f32 v20, -v37, v19, v20
  v_fma_f32 v21, v37, v18, v21
  v_cndmask_b32 v18, v18, v20, vcc
  v_cndmask_b32 v19, v19, v21, vcc
  v_fma_f32 v20, v36, v18, v196
  v_fma_f32 v21, v36, v19, v197
  v_cmp_lt_u32 vcc, 2, v22
  v_fma_f32 v20, -v37, v19, v20
  v_fma_f32 v21, v37, v18, v21
  v_cndmask_b32 v18, v18, v20, vcc
  v_cndmask_b32 v19, v19, v21, vcc
  v_fma_f32 v20, v36, v18, v198
  v_fma_f32 v21, v36, v19, v199
  v_cmp_lt_u32 vcc, 3, v22
  v_fma_f32 v20, -v37, v19, v20
  v_fma_f32 v21, v37, v18, v21
  v_cndmask_b32 v18, v18, v20, vcc
  v_cndmask_b32 v19, v19, v21, vcc
  v_fma_f32 v20, v36, v18, v200
  v_fma_f32 v21, v36, v19, v201
  v_cmp_lt_u32 vcc, 4, v22
  v_fma_f32 v20, -v37, v19, v20
  v_fma_f32 v21, v37, v18, v21
  v_cndmask_b32 v18, v18, v20, vcc
  v_cndmask_b32 v19, v19, v21, vcc
  v_fma_f32 v20, v36, v18, v202
  v_fma_f32 v21, v36, v19, v203
  v_cmp_lt_u32 vcc, 5, v22
  v_fma_f32 v20, -v37, v19, v20
  v_fma_f32 v21, v37, v18, v21
  v_cndmask_b32 v18, v18, v20, vcc
  v_cndmask_b32 v19, v19, v21, vcc
  v_fma_f32 v20, v36, v18, v204
  v_fma_f32 v21, v36, v19, v205
  v_cmp_lt_u32 vcc, 6, v22
  v_fma_f32 v20, -v37, v19, v20
  v_fma_f32 v21, v37, v18, v21
  v_cndmask_b32 v18, v18, v20, vcc
  v_cndmask_b32 v19, v19, v21, vcc
  v_fma_f32 v20, v32, v18, v64
  v_fma_f32 v21, v32, v19, v80
  v_fma_f32 v20, -v33, v19, v20
  v_fma_f32 v21, v33, v18, v21
  v_mul_f32 v64, v34, v20
  v_mul_f32 v80, -v34, v21
  v_fma_f32 v64, -v35, v21, v64
  v_fma_f32 v80, -v35, v20, v80
  v_fma_f32 v18, v32, v20, v65
  v_fma_f32 v19, v32, v21, v81
  v_fma_f32 v18, -v33, v21, v18
  v_fma_f32 v19, v33, v20, v19
  v_mul_f32 v65, v34, v18
  v_mul_f32 v81, -v34, v19
  v_fma_f32 v65, -v35, v19, v65
  v_fma_f32 v81, -v35, v18, v81
  v_fma_f32 v20, v32, v18, v66
  v_fma_f32 v21, v32, v19, v82
  v_fma_f32 v20, -v33, v19, v20
  v_fma_f32 v21, v33, v18, v21
  v_mul_f32 v66, v34, v20
  v_mul_f32 v82, -v34, v21
  v_fma_f32 v66, -v35, v21, v66
  v_fma_f32 v82, -v35, v20, v82
  v_fma_f32 v18, v32, v20, v67
  v_fma_f32 v19, v32, v21, v83
  v_fma_f32 v18, -v33, v21, v18
  v_fma_f32 v19, v33, v20, v19
  v_mul_f32 v67, v34, v18
  v_mul_f32 v83, -v34, v19
  v_fma_f32 v67, -v35, v19, v67
  v_fma_f32 v83, -v35, v18, v83
  v_fma_f32 v20, v32, v18, v68
  v_fma_f32 v21, v32, v19, v84
  v_fma_f32 v20, -v33, v19, v20
  v_fma_f32 v21, v33, v18, v21
  v_mul_f32 v68, v34, v20
  v_mul_f32 v84, -v34, v21
  v_fma_f32 v68, -v35, v21, v68
  v_fma_f32 v84, -v35, v20, v84
  v_fma_f32 v18, v32, v20, v69
  v_fma_f32 v19, v32, v21, v85
  v_fma_f32 v18, -v33, v21, v18
  v_fma_f32 v19, v33, v20, v19
  v_mul_f32 v69, v34, v18
  v_mul_f32 v85, -v34, v19
  v_fma_f32 v69, -v35, v19, v69
  v_fma_f32 v85, -v35, v18, v85
  v_fma_f32 v20, v32, v18, v70
  v_fma_f32 v21, v32, v19, v86
  v_fma_f32 v20, -v33, v19, v20
  v_fma_f32 v21, v33, v18, v21
  v_mul_f32 v70, v34, v20
  v_mul_f32 v86, -v34, v21
  v_fma_f32 v70, -v35, v21, v70
  v_fma_f32 v86, -v35, v20, v86
  v_fma_f32 v18, v32, v20, v71
  v_fma_f32 v19, v32, v21, v87
  v_fma_f32 v18, -v33, v21, v18
  v_fma_f32 v19, v33, v20, v19
  v_mul_f32 v71, v34, v18
  v_mul_f32 v87, -v34, v19
  v_fma_f32 v71, -v35, v19, v71
  v_fma_f32 v87, -v35, v18, v87
  v_fma_f32 v20, v32, v18, v72
  v_fma_f32 v21, v32, v19, v88
  v_fma_f32 v20, -v33, v19, v20
  v_fma_f32 v21, v33, v18, v21
  v_mul_f32 v72, v34, v20
  v_mul_f32 v88, -v34, v21
  v_fma_f32 v72, -v35, v21, v72
  v_fma_f32 v88, -v35, v20, v88
  v_fma_f32 v18, v32, v20, v73
  v_fma_f32 v19, v32, v21, v89
  v_fma_f32 v18, -v33, v21, v18
  v_fma_f32 v19, v33, v20, v19
  v_mul_f32 v73, v34, v18
  v_mul_f32 v89, -v34, v19
  v_fma_f32 v73, -v35, v19, v73
  v_fma_f32 v89, -v35, v18, v89
  v_fma_f32 v20, v32, v18, v74
  v_fma_f32 v21, v32, v19, v90
  v_fma_f32 v20, -v33, v19, v20
  v_fma_f32 v21, v33, v18, v21
  v_mul_f32 v74, v34, v20
  v_mul_f32 v90, -v34, v21
  v_fma_f32 v74, -v35, v21, v74
  v_fma_f32 v90, -v35, v20, v90
  v_fma_f32 v18, v32, v20, v75
  v_fma_f32 v19, v32, v21, v91
  v_fma_f32 v18, -v33, v21, v18
  v_fma_f32 v19, v33, v20, v19
  v_mul_f32 v75, v34, v18
  v_mul_f32 v91, -v34, v19
  v_fma_f32 v75, -v35, v19, v75
  v_fma_f32 v91, -v35, v18, v91
  v_fma_f32 v20, v32, v18, v76
  v_fma_f32 v21, v32, v19, v92
  v_fma_f32 v20, -v33, v19, v20
  v_fma_f32 v21, v33, v18, v21
  v_mul_f32 v76, v34, v20
  v_mul_f32 v92, -v34, v21
  v_fma_f32 v76, -v35, v21, v76
  v_fma_f32 v92, -v35, v20, v92
  v_fma_f32 v18, v32, v20, v77
  v_fma_f32 v19, v32, v21, v93
  v_fma_f32 v18, -v33, v21, v18
  v_fma_f32 v19, v33, v20, v19
  v_mul_f32 v77, v34, v18
  v_mul_f32 v93, -v34, v19
  v_fma_f32 v77, -v35, v19, v77
  v_fma_f32 v93, -v35, v18, v93
  v_fma_f32 v20, v32, v18, v78
  v_fma_f32 v21, v32, v19, v94
  v_fma_f32 v20, -v33, v19, v20
  v_fma_f32 v21, v33, v18, v21
  v_mul_f32 v78, v34, v20
  v_mul_f32 v94, -v34, v21
  v_fma_f32 v78, -v35, v21, v78
  v_fma_f32 v94, -v35, v20, v94
  v_fma_f32 v18, v32, v20, v79
  v_fma_f32 v19, v32, v21, v95
  v_fma_f32 v18, -v33, v21, v18
  v_fma_f32 v19, v33, v20, v19
  v_mul_f32 v79, v34, v18
  v_mul_f32 v95, -v34, v19
  v_fma_f32 v79, -v35, v19, v79
  v_fma_f32 v95, -v35, v18, v95
  v_cvt_pk_bf16_f32 v160, v64, v65
  v_cvt_pk_bf16_f32 v168, v80, v81
  v_cvt_pk_bf16_f32 v161, v66, v67
  v_cvt_pk_bf16_f32 v169, v82, v83
  v_cvt_pk_bf16_f32 v162, v68, v69
  v_cvt_pk_bf16_f32 v170, v84, v85
  v_cvt_pk_bf16_f32 v163, v70, v71
  v_cvt_pk_bf16_f32 v171, v86, v87
  v_cvt_pk_bf16_f32 v164, v72, v73
  v_cvt_pk_bf16_f32 v172, v88, v89
  v_cvt_pk_bf16_f32 v165, v74, v75
  v_cvt_pk_bf16_f32 v173, v90, v91
  v_cvt_pk_bf16_f32 v166, v76, v77
  v_cvt_pk_bf16_f32 v174, v92, v93
  v_cvt_pk_bf16_f32 v167, v78, v79
  v_cvt_pk_bf16_f32 v175, v94, v95
  v_lshlrev_b32 v23, 12, v2
  v_add_u32 v23, 131072, v23
  v_lshrrev_b32 v22, 5, v1
  v_lshlrev_b32 v22, 3, v22
  v_lshl_add_u32 v22, v25, 6, v22
  v_add_u32 v22, v23, v22
  v_add_u32 v23, v23, v0
  v_lshlrev_b32 v17, 4, v1
  ds_write_b64 v22, v[160:161] offset:0
  ds_write_b64 v22, v[162:163] offset:16
  ds_write_b64 v22, v[164:165] offset:32
  ds_write_b64 v22, v[166:167] offset:48
  ds_write_b64 v22, v[168:169] offset:2048
  ds_write_b64 v22, v[170:171] offset:2064
  ds_write_b64 v22, v[172:173] offset:2080
  ds_write_b64 v22, v[174:175] offset:2096
  s_waitcnt lgkmcnt(0)
  ds_read_b64_tr_b16 v[176:177], v23 offset:0
  ds_read_b64_tr_b16 v[178:179], v23 offset:256
  ds_read_b64_tr_b16 v[180:181], v23 offset:1024
  ds_read_b64_tr_b16 v[182:183], v23 offset:1280
  ds_read_b64_tr_b16 v[184:185], v23 offset:2048
  ds_read_b64_tr_b16 v[186:187], v23 offset:2304
  ds_read_b64_tr_b16 v[188:189], v23 offset:3072
  ds_read_b64_tr_b16 v[190:191], v23 offset:3328
  s_waitcnt lgkmcnt(0)
  buffer_store_dwordx4 v[176:179], v17, s[16:19], s84 offen offset:0 sc1
  buffer_store_dwordx4 v[180:183], v17, s[16:19], s84 offen offset:1024 sc1
  buffer_store_dwordx4 v[184:187], v17, s[16:19], s84 offen offset:2048 sc1
  buffer_store_dwordx4 v[188:191], v17, s[16:19], s84 offen offset:3072 sc1
  s_barrier
  s_mov_b32 s77, 0
  buffer_load_dwordx4 v[128:131], v42, s[16:19], s77 offen sc1
  buffer_load_dwordx4 v[132:135], v42, s[16:19], s77 offen offset:1024 sc1
  s_mov_b32 s77, 8192
  buffer_load_dwordx4 v[136:139], v42, s[16:19], s77 offen sc1
  buffer_load_dwordx4 v[140:143], v42, s[16:19], s77 offen offset:1024 sc1
  s_mov_b32 s77, 16384
  buffer_load_dwordx4 v[144:147], v42, s[16:19], s77 offen sc1
  buffer_load_dwordx4 v[148:151], v42, s[16:19], s77 offen offset:1024 sc1
  s_mov_b32 s77, 24576
  buffer_load_dwordx4 v[152:155], v42, s[16:19], s77 offen sc1
  buffer_load_dwordx4 v[156:159], v42, s[16:19], s77 offen offset:1024 sc1
  s_lshl_b32 s81, s39, 11
  s_add_u32 s81, s81, s101
  s_add_u32 s81, s81, 32768
  s_lshl_b32 s81, s39, 11
  s_add_u32 s81, s81, s101
  s_add_u32 s81, s81, 32768
  v_mov_b32 v46, 3184710632
  v_and_b32 v17, 31, v1
  v_lshlrev_b32 v17, 2, v17
  v_add_u32 v17, 147968, v17
  ds_read_b32 v18, v17 offset:0
  ds_read_b32 v19, v17 offset:128
  v_cmp_gt_u32 vcc, 32, v1
  v_mov_b32 v50, 0
  v_mov_b32 v51, 0
  v_cndmask_b32 v48, 0, v41, vcc
  v_mov_b32 v54, 0
  v_lshrrev_b32 v49, 16, v48
  v_mov_b32 v55, 0
  v_or_b32 v48, v48, v49
  s_waitcnt lgkmcnt(0)
  v_cvt_pk_bf16_f32 v20, v18, v18
  v_lshlrev_b32 v20, 16, v20
  v_sub_f32 v20, v18, v20
  v_cvt_pk_bf16_f32 v52, v18, v20
  v_and_b32 v53, 0xffff0000, v52
  v_sub_f32 v20, v20, v53
  v_cvt_pk_bf16_f32 v53, v20, v54
  s_nop 1
  v_mfma_f32_32x32x16_bf16 v[96:111], v[52:55], v[48:51], v[96:111]
  v_cvt_pk_bf16_f32 v20, v19, v19
  v_lshlrev_b32 v20, 16, v20
  v_sub_f32 v20, v19, v20
  v_cvt_pk_bf16_f32 v52, v19, v20
  v_and_b32 v53, 0xffff0000, v52
  v_sub_f32 v20, v20, v53
  v_cvt_pk_bf16_f32 v53, v20, v54
  s_nop 1
  v_mfma_f32_32x32x16_bf16 v[112:127], v[52:55], v[48:51], v[112:127]
  s_nop 15
  s_nop 3
  v_mul_f32 v96, v96, v40
  v_mul_f32 v97, v97, v40
  v_mul_f32 v98, v98, v40
  v_mul_f32 v99, v99, v40
  v_mul_f32 v17, v96, v96
  v_mul_f32 v18, v97, v97
  v_mul_f32 v19, v98, v98
  v_mul_f32 v20, v99, v99
  v_fmaak_f32 v17, v46, v17, 3222493025
  v_fmaak_f32 v18, v46, v18, 3222493025
  v_fmaak_f32 v19, v46, v19, 3222493025
  v_fmaak_f32 v20, v46, v20, 3222493025
  v_mul_f32 v17, v17, v96
  v_mul_f32 v18, v18, v97
  v_mul_f32 v19, v19, v98
  v_mul_f32 v20, v20, v99
  v_exp_f32 v17, v17
  v_exp_f32 v18, v18
  v_exp_f32 v19, v19
  v_exp_f32 v20, v20
  v_mul_f32 v21, v96, v112
  v_mul_f32 v22, v97, v113
  v_mul_f32 v23, v98, v114
  v_mul_f32 v24, v99, v115
  v_add_f32 v17, 1.0, v17
  v_add_f32 v18, 1.0, v18
  v_add_f32 v19, 1.0, v19
  v_add_f32 v20, 1.0, v20
  v_rcp_f32 v17, v17
  v_rcp_f32 v18, v18
  v_rcp_f32 v19, v19
  v_rcp_f32 v20, v20
  v_mul_f32 v21, v21, v40
  v_mul_f32 v22, v22, v40
  v_mul_f32 v23, v23, v40
  v_mul_f32 v24, v24, v40
  v_mul_f32 v17, v17, v21
  v_mul_f32 v18, v18, v22
  v_mul_f32 v19, v19, v23
  v_mul_f32 v20, v20, v24
  v_cvt_pk_bf16_f32 v96, v17, v18
  v_cvt_pk_bf16_f32 v97, v19, v20
  v_mul_f32 v100, v100, v40
  v_mul_f32 v101, v101, v40
  v_mul_f32 v102, v102, v40
  v_mul_f32 v103, v103, v40
  v_mul_f32 v17, v100, v100
  v_mul_f32 v18, v101, v101
  v_mul_f32 v19, v102, v102
  v_mul_f32 v20, v103, v103
  v_fmaak_f32 v17, v46, v17, 3222493025
  v_fmaak_f32 v18, v46, v18, 3222493025
  v_fmaak_f32 v19, v46, v19, 3222493025
  v_fmaak_f32 v20, v46, v20, 3222493025
  v_mul_f32 v17, v17, v100
  v_mul_f32 v18, v18, v101
  v_mul_f32 v19, v19, v102
  v_mul_f32 v20, v20, v103
  v_exp_f32 v17, v17
  v_exp_f32 v18, v18
  v_exp_f32 v19, v19
  v_exp_f32 v20, v20
  v_mul_f32 v21, v100, v116
  v_mul_f32 v22, v101, v117
  v_mul_f32 v23, v102, v118
  v_mul_f32 v24, v103, v119
  v_add_f32 v17, 1.0, v17
  v_add_f32 v18, 1.0, v18
  v_add_f32 v19, 1.0, v19
  v_add_f32 v20, 1.0, v20
  v_rcp_f32 v17, v17
  v_rcp_f32 v18, v18
  v_rcp_f32 v19, v19
  v_rcp_f32 v20, v20
  v_mul_f32 v21, v21, v40
  v_mul_f32 v22, v22, v40
  v_mul_f32 v23, v23, v40
  v_mul_f32 v24, v24, v40
  v_mul_f32 v17, v17, v21
  v_mul_f32 v18, v18, v22
  v_mul_f32 v19, v19, v23
  v_mul_f32 v20, v20, v24
  v_cvt_pk_bf16_f32 v98, v17, v18
  v_cvt_pk_bf16_f32 v99, v19, v20
  v_mul_f32 v104, v104, v40
  v_mul_f32 v105, v105, v40
  v_mul_f32 v106, v106, v40
  v_mul_f32 v107, v107, v40
  v_mul_f32 v17, v104, v104
  v_mul_f32 v18, v105, v105
  v_mul_f32 v19, v106, v106
  v_mul_f32 v20, v107, v107
  v_fmaak_f32 v17, v46, v17, 3222493025
  v_fmaak_f32 v18, v46, v18, 3222493025
  v_fmaak_f32 v19, v46, v19, 3222493025
  v_fmaak_f32 v20, v46, v20, 3222493025
  v_mul_f32 v17, v17, v104
  v_mul_f32 v18, v18, v105
  v_mul_f32 v19, v19, v106
  v_mul_f32 v20, v20, v107
  v_exp_f32 v17, v17
  v_exp_f32 v18, v18
  v_exp_f32 v19, v19
  v_exp_f32 v20, v20
  v_mul_f32 v21, v104, v120
  v_mul_f32 v22, v105, v121
  v_mul_f32 v23, v106, v122
  v_mul_f32 v24, v107, v123
  v_add_f32 v17, 1.0, v17
  v_add_f32 v18, 1.0, v18
  v_add_f32 v19, 1.0, v19
  v_add_f32 v20, 1.0, v20
  v_rcp_f32 v17, v17
  v_rcp_f32 v18, v18
  v_rcp_f32 v19, v19
  v_rcp_f32 v20, v20
  v_mul_f32 v21, v21, v40
  v_mul_f32 v22, v22, v40
  v_mul_f32 v23, v23, v40
  v_mul_f32 v24, v24, v40
  v_mul_f32 v17, v17, v21
  v_mul_f32 v18, v18, v22
  v_mul_f32 v19, v19, v23
  v_mul_f32 v20, v20, v24
  v_cvt_pk_bf16_f32 v100, v17, v18
  v_cvt_pk_bf16_f32 v101, v19, v20
  v_mul_f32 v108, v108, v40
  v_mul_f32 v109, v109, v40
  v_mul_f32 v110, v110, v40
  v_mul_f32 v111, v111, v40
  v_mul_f32 v17, v108, v108
  v_mul_f32 v18, v109, v109
  v_mul_f32 v19, v110, v110
  v_mul_f32 v20, v111, v111
  v_fmaak_f32 v17, v46, v17, 3222493025
  v_fmaak_f32 v18, v46, v18, 3222493025
  v_fmaak_f32 v19, v46, v19, 3222493025
  v_fmaak_f32 v20, v46, v20, 3222493025
  v_mul_f32 v17, v17, v108
  v_mul_f32 v18, v18, v109
  v_mul_f32 v19, v19, v110
  v_mul_f32 v20, v20, v111
  v_exp_f32 v17, v17
  v_exp_f32 v18, v18
  v_exp_f32 v19, v19
  v_exp_f32 v20, v20
  v_mul_f32 v21, v108, v124
  v_mul_f32 v22, v109, v125
  v_mul_f32 v23, v110, v126
  v_mul_f32 v24, v111, v127
  v_add_f32 v17, 1.0, v17
  v_add_f32 v18, 1.0, v18
  v_add_f32 v19, 1.0, v19
  v_add_f32 v20, 1.0, v20
  v_rcp_f32 v17, v17
  v_rcp_f32 v18, v18
  v_rcp_f32 v19, v19
  v_rcp_f32 v20, v20
  v_mul_f32 v21, v21, v40
  v_mul_f32 v22, v22, v40
  v_mul_f32 v23, v23, v40
  v_mul_f32 v24, v24, v40
  v_mul_f32 v17, v17, v21
  v_mul_f32 v18, v18, v22
  v_mul_f32 v19, v19, v23
  v_mul_f32 v20, v20, v24
  v_cvt_pk_bf16_f32 v102, v17, v18
  v_cvt_pk_bf16_f32 v103, v19, v20
  v_lshlrev_b32 v17, 4, v1
  buffer_store_dwordx4 v[96:99], v17, s[16:19], s81 offen sc1
  buffer_store_dwordx4 v[100:103], v17, s[16:19], s81 offen offset:1024 sc1
  s_add_u32 s77, s100, 0
  s_add_u32 m0, s89, 65536
  s_nop 0
  buffer_load_dwordx4 v44, s[24:27], s77 offen lds
  s_add_u32 s77, s100, 8192
  s_add_u32 m0, s89, 66560
  s_nop 0
  buffer_load_dwordx4 v45, s[24:27], s77 offen lds
  s_add_u32 s77, s100, 128
  s_add_u32 m0, s89, 81920
  s_nop 0
  buffer_load_dwordx4 v44, s[24:27], s77 offen lds
  s_add_u32 s77, s100, 8320
  s_add_u32 m0, s89, 82944
  s_nop 0
  buffer_load_dwordx4 v45, s[24:27], s77 offen lds
  s_add_u32 s77, s100, 256
  s_add_u32 m0, s89, 98304
  s_nop 0
  buffer_load_dwordx4 v44, s[24:27], s77 offen lds
  s_add_u32 s77, s100, 8448
  s_add_u32 m0, s89, 99328
  s_nop 0
  buffer_load_dwordx4 v45, s[24:27], s77 offen lds
  s_add_u32 s77, s100, 384
  s_add_u32 m0, s89, 114688
  s_nop 0
  buffer_load_dwordx4 v44, s[24:27], s77 offen lds
  s_add_u32 s77, s100, 8576
  s_add_u32 m0, s89, 115712
  s_nop 0
  buffer_load_dwordx4 v45, s[24:27], s77 offen lds
  s_waitcnt vmcnt(18)
  s_lshl_b32 s76, s38, 11
  s_lshl_b32 s77, s39, 4
  s_add_u32 s76, s76, s77
  s_lshl_b32 s77, s37, 2
  s_add_u32 s76, s76, s77
  s_add_u32 s76, s76, 11535360
  v_mov_b32 v26, 0
  v_mov_b32 v27, s75
  s_mov_b64 s[92:93], exec
  s_mov_b64 exec, 1
  buffer_store_dword v27, v26, s[16:19], s76 offen sc1
  s_mov_b64 exec, s[92:93]
  v_lshrrev_b32 v17, 5, v1
  v_lshlrev_b32 v17, 2, v17
  v_bfe_u32 v3, v1, 2, 2
  v_add_u32 v17, v17, v3
  v_lshlrev_b32 v17, 7, v17
  v_bfe_u32 v3, v1, 3, 1
  v_lshl_add_u32 v17, v3, 6, v17
  v_bfe_u32 v3, v1, 4, 1
  v_lshl_add_u32 v17, v3, 5, v17
  v_and_b32 v3, 3, v1
  v_lshl_add_u32 v17, v3, 3, v17
  s_lshl_b32 s76, s37, 12
  v_add_u32 v4, s76, v17
  v_xor_b32 v5, 64, v4
  v_and_b32 v17, 31, v1
  v_bfe_u32 v3, v17, 1, 3
  v_lshrrev_b32 v18, 5, v1
  s_lshr_b32 s76, s37, 1
  s_lshl_b32 s76, s76, 2
  v_add_u32 v18, s76, v18
  v_xor_b32 v3, v3, v18
  v_lshlrev_b32 v17, 7, v17
  v_lshl_add_u32 v17, v3, 4, v17
  s_and_b32 s76, s37, 1
  s_lshl_b32 s76, s76, 13
  v_add_u32 v6, s76, v17
  v_xor_b32 v7, 32, v6
  v_lshrrev_b32 v17, 5, v1
  v_lshlrev_b32 v17, 4, v17
  s_lshl_b32 s76, s87, 6
  s_lshl_b32 s77, s37, 2
  s_add_u32 s76, s76, s77
  s_add_u32 s76, s76, 0
  v_add_u32 v17, s76, v17
  v_lshlrev_b32 v11, 4, v17
  v_lshlrev_b32 v17, 9, v17
  v_and_b32 v3, 31, v1
  s_lshl_b32 s76, s88, 6
  v_add_u32 v3, s76, v3
  v_add_u32 v17, v17, v3
  v_lshlrev_b32 v9, 1, v17
  v_lshlrev_b32 v12, 1, v3
  v_mov_b32 v208, 0
  v_mov_b32 v209, 0
  v_mov_b32 v210, 0
  v_mov_b32 v211, 0
  v_mov_b32 v212, 0
  v_mov_b32 v213, 0
  v_mov_b32 v214, 0
  v_mov_b32 v215, 0
  v_mov_b32 v216, 0
  v_mov_b32 v217, 0
  v_mov_b32 v218, 0
  v_mov_b32 v219, 0
  v_mov_b32 v220, 0
  v_mov_b32 v221, 0
  v_mov_b32 v222, 0
  v_mov_b32 v223, 0
  v_mov_b32 v224, 0
  v_mov_b32 v225, 0
  v_mov_b32 v226, 0
  v_mov_b32 v227, 0
  v_mov_b32 v228, 0
  v_mov_b32 v229, 0
  v_mov_b32 v230, 0
  v_mov_b32 v231, 0
  v_mov_b32 v232, 0
  v_mov_b32 v233, 0
  v_mov_b32 v234, 0
  v_mov_b32 v235, 0
  v_mov_b32 v236, 0
  v_mov_b32 v237, 0
  v_mov_b32 v238, 0
  v_mov_b32 v239, 0
  buffer_load_ushort v8, v12, s[32:35], 0 offen
  buffer_load_ushort v10, v12, s[32:35], 0 offen offset:64
  buffer_load_ushort v104, v9, s[4:7], 0 offen offset:0
  buffer_load_ushort v105, v9, s[4:7], 0 offen offset:1024
  buffer_load_ushort v106, v9, s[4:7], 0 offen offset:2048
  buffer_load_ushort v107, v9, s[4:7], 0 offen offset:3072
  buffer_load_ushort v108, v9, s[4:7], 0 offen offset:64
  buffer_load_ushort v109, v9, s[4:7], 0 offen offset:1088
  buffer_load_ushort v110, v9, s[4:7], 0 offen offset:2112
  buffer_load_ushort v111, v9, s[4:7], 0 offen offset:3136
  s_mov_b32 s76, 10747904
  buffer_load_dword v112, v11, s[16:19], s76 offen offset:0 sc1
  buffer_load_dword v116, v11, s[16:19], s76 offen offset:8 sc1
  buffer_load_dword v113, v11, s[16:19], s76 offen offset:16 sc1
  buffer_load_dword v117, v11, s[16:19], s76 offen offset:24 sc1
  buffer_load_dword v114, v11, s[16:19], s76 offen offset:32 sc1
  buffer_load_dword v118, v11, s[16:19], s76 offen offset:40 sc1
  buffer_load_dword v115, v11, s[16:19], s76 offen offset:48 sc1
  buffer_load_dword v119, v11, s[16:19], s76 offen offset:56 sc1
  s_barrier
  ds_read_b64_tr_b16 v[176:177], v4 offset:0
  ds_read_b64_tr_b16 v[178:179], v4 offset:1024
  ds_read_b64_tr_b16 v[180:181], v5 offset:0
  ds_read_b64_tr_b16 v[182:183], v5 offset:1024
  ds_read_b64_tr_b16 v[184:185], v4 offset:2048
  ds_read_b64_tr_b16 v[186:187], v4 offset:3072
  ds_read_b64_tr_b16 v[188:189], v5 offset:2048
  ds_read_b64_tr_b16 v[190:191], v5 offset:3072
  s_barrier
  s_waitcnt vmcnt(35)
  s_waitcnt lgkmcnt(6)
  v_mfma_f32_32x32x16_bf16 v[208:223], v[128:131], v[176:179], v[208:223]
  ds_read_b64_tr_b16 v[192:193], v4 offset:16384
  ds_read_b64_tr_b16 v[194:195], v4 offset:17408
  s_waitcnt lgkmcnt(6)
  v_mfma_f32_32x32x16_bf16 v[224:239], v[128:131], v[180:183], v[224:239]
  ds_read_b64_tr_b16 v[196:197], v5 offset:16384
  ds_read_b64_tr_b16 v[198:199], v5 offset:17408
  s_waitcnt lgkmcnt(6)
  v_mfma_f32_32x32x16_bf16 v[208:223], v[132:135], v[184:187], v[208:223]
  ds_read_b64_tr_b16 v[200:201], v4 offset:18432
  ds_read_b64_tr_b16 v[202:203], v4 offset:19456
  s_waitcnt lgkmcnt(6)
  v_mfma_f32_32x32x16_bf16 v[224:239], v[132:135], v[188:191], v[224:239]
  ds_read_b64_tr_b16 v[204:205], v5 offset:18432
  ds_read_b64_tr_b16 v[206:207], v5 offset:19456
  s_waitcnt vmcnt(27)
  s_lshl_b32 s76, s38, 11
  s_lshl_b32 s77, s39, 5
  s_add_u32 s76, s76, s77
  s_lshl_b32 s77, s36, 2
  s_add_u32 s76, s76, s77
  s_add_u32 s76, s76, 11534848
  v_mov_b32 v26, 0
  v_mov_b32 v27, s75
  s_mov_b64 s[92:93], exec
  s_mov_b64 exec, 1
  buffer_store_dword v27, v26, s[16:19], s76 offen sc1
  s_mov_b64 exec, s[92:93]
  s_barrier
  s_waitcnt lgkmcnt(6)
  v_mfma_f32_32x32x16_bf16 v[208:223], v[136:139], v[192:195], v[208:223]
  ds_read_b64_tr_b16 v[176:177], v4 offset:32768
  ds_read_b64_tr_b16 v[178:179], v4 offset:33792
  s_add_u32 s77, s100, 512
  s_add_u32 m0, s89, 0
  s_nop 0
  buffer_load_dwordx4 v44, s[24:27], s77 offen lds
  s_waitcnt lgkmcnt(6)
  v_mfma_f32_32x32x16_bf16 v[224:239], v[136:139], v[196:199], v[224:239]
  ds_read_b64_tr_b16 v[180:181], v5 offset:32768
  ds_read_b64_tr_b16 v[182:183], v5 offset:33792
  s_add_u32 s77, s100, 8704
  s_add_u32 m0, s89, 1024
  s_nop 0
  buffer_load_dwordx4 v45, s[24:27], s77 offen lds
  s_waitcnt lgkmcnt(6)
  v_mfma_f32_32x32x16_bf16 v[208:223], v[140:143], v[200:203], v[208:223]
  ds_read_b64_tr_b16 v[184:185], v4 offset:34816
  ds_read_b64_tr_b16 v[186:187], v4 offset:35840
  s_waitcnt lgkmcnt(6)
  v_mfma_f32_32x32x16_bf16 v[224:239], v[140:143], v[204:207], v[224:239]
  ds_read_b64_tr_b16 v[188:189], v5 offset:34816
  ds_read_b64_tr_b16 v[190:191], v5 offset:35840
  s_lshr_b32 s76, s87, 1
  s_lshl_b32 s76, s76, 11
  s_add_u32 s76, s76, 11535360
  v_lshlrev_b32 v17, 2, v1
  s_mov_b32 s91, 0
  buffer_load_dword v248, v17, s[16:19], s76 offen sc1
  s_sleep 2
  buffer_load_dword v250, v17, s[16:19], s76 offen sc1
  s_sleep 2
  buffer_load_dword v252, v17, s[16:19], s76 offen sc1
  s_sleep 2
PF_34:
  s_waitcnt vmcnt(2)
  v_cmp_ne_u32 vcc, s75, v248
  s_add_u32 s91, s91, 1
  s_cbranch_vccz PFOK_35
  buffer_load_dword v248, v17, s[16:19], s76 offen sc1
  s_waitcnt vmcnt(2)
  v_cmp_ne_u32 vcc, s75, v250
  s_add_u32 s91, s91, 1
  s_cbranch_vccz PFOK_35
  buffer_load_dword v250, v17, s[16:19], s76 offen sc1
  s_waitcnt vmcnt(2)
  v_cmp_ne_u32 vcc, s75, v252
  s_add_u32 s91, s91, 1
  s_cbranch_vccz PFOK_35
  buffer_load_dword v252, v17, s[16:19], s76 offen sc1
  s_cmp_gt_u32 s91, 200000
  s_cbranch_scc0 PF_34
PFOK_35:
  s_barrier
  s_waitcnt lgkmcnt(6)
  v_mfma_f32_32x32x16_bf16 v[208:223], v[144:147], v[176:179], v[208:223]
  ds_read_b64_tr_b16 v[192:193], v4 offset:49152
  ds_read_b64_tr_b16 v[194:195], v4 offset:50176
  s_mov_b32 s77, 88064
  buffer_load_dwordx4 v[160:163], v42, s[16:19], s77 offen sc1
  buffer_load_dwordx4 v[164:167], v42, s[16:19], s77 offen offset:1024 sc1
  s_waitcnt lgkmcnt(6)
  v_mfma_f32_32x32x16_bf16 v[224:239], v[144:147], v[180:183], v[224:239]
  ds_read_b64_tr_b16 v[196:197], v5 offset:49152
  ds_read_b64_tr_b16 v[198:199], v5 offset:50176
  s_mov_b32 s77, 96256
  buffer_load_dwordx4 v[168:171], v42, s[16:19], s77 offen sc1
  buffer_load_dwordx4 v[172:175], v42, s[16:19], s77 offen offset:1024 sc1
  s_waitcnt lgkmcnt(6)
  v_mfma_f32_32x32x16_bf16 v[208:223], v[148:151], v[184:187], v[208:223]
  ds_read_b64_tr_b16 v[200:201], v4 offset:51200
  ds_read_b64_tr_b16 v[202:203], v4 offset:52224
  s_mov_b32 s77, 104448
  buffer_load_dwordx4 v[64:67], v42, s[16:19], s77 offen sc1
  buffer_load_dwordx4 v[68:71], v42, s[16:19], s77 offen offset:1024 sc1
  s_waitcnt lgkmcnt(6)
  v_mfma_f32_32x32x16_bf16 v[224:239], v[148:151], v[188:191], v[224:239]
  ds_read_b64_tr_b16 v[204:205], v5 offset:51200
  ds_read_b64_tr_b16 v[206:207], v5 offset:52224
  s_add_u32 s77, s100, 640
  s_add_u32 m0, s89, 16384
  s_nop 0
  buffer_load_dwordx4 v44, s[24:27], s77 offen lds
  s_add_u32 s77, s100, 8832
  s_add_u32 m0, s89, 17408
  s_nop 0
  buffer_load_dwordx4 v45, s[24:27], s77 offen lds
  s_lshr_b32 s76, s87, 1
  s_lshl_b32 s76, s76, 11
  s_add_u32 s76, s76, 11534848
  v_lshlrev_b32 v17, 3, v1
  buffer_load_dwordx2 v[244:245], v17, s[16:19], s76 offen sc1
  s_barrier
  s_waitcnt lgkmcnt(6)
  v_mfma_f32_32x32x16_bf16 v[208:223], v[152:155], v[192:195], v[208:223]
  v_xor_b32 v4, 0x10000, v4
  v_xor_b32 v5, 0x10000, v5
  v_xor_b32 v6, 0x10000, v6
  v_xor_b32 v7, 0x10000, v7
  ds_read_b128 v[176:179], v6 offset:0
  s_mov_b32 s77, 112640
  buffer_load_dwordx4 v[72:75], v42, s[16:19], s77 offen sc1
  buffer_load_dwordx4 v[76:79], v42, s[16:19], s77 offen offset:1024 sc1
  s_waitcnt lgkmcnt(5)
  v_mfma_f32_32x32x16_bf16 v[224:239], v[152:155], v[196:199], v[224:239]
  ds_read_b128 v[180:183], v6 offset:4096
  s_mov_b32 s77, 120832
  buffer_load_dwordx4 v[80:83], v42, s[16:19], s77 offen sc1
  buffer_load_dwordx4 v[84:87], v42, s[16:19], s77 offen offset:1024 sc1
  s_waitcnt lgkmcnt(4)
  v_mfma_f32_32x32x16_bf16 v[208:223], v[156:159], v[200:203], v[208:223]
  ds_read_b128 v[184:187], v7 offset:0
  s_mov_b32 s77, 129024
  buffer_load_dwordx4 v[88:91], v42, s[16:19], s77 offen sc1
  buffer_load_dwordx4 v[92:95], v42, s[16:19], s77 offen offset:1024 sc1
  s_waitcnt lgkmcnt(3)
  v_mfma_f32_32x32x16_bf16 v[224:239], v[156:159], v[204:207], v[224:239]
  ds_read_b128 v[188:191], v7 offset:4096
  s_add_u32 s77, s100, 768
  s_add_u32 m0, s89, 32768
  s_nop 0
  buffer_load_dwordx4 v44, s[24:27], s77 offen lds
  s_add_u32 s77, s100, 8960
  s_add_u32 m0, s89, 33792
  s_nop 0
  buffer_load_dwordx4 v45, s[24:27], s77 offen lds
  s_barrier
  s_waitcnt vmcnt(15)
  s_waitcnt lgkmcnt(3)
  v_mfma_f32_32x32x16_bf16 v[208:223], v[160:163], v[176:179], v[208:223]
  ds_read_b128 v[192:195], v6 offset:16384
  s_mov_b32 s77, 137216
  buffer_load_dwordx4 v[128:131], v42, s[16:19], s77 offen sc1
  buffer_load_dwordx4 v[132:135], v42, s[16:19], s77 offen offset:1024 sc1
  s_waitcnt lgkmcnt(3)
  v_mfma_f32_32x32x16_bf16 v[224:239], v[160:163], v[180:183], v[224:239]
  ds_read_b128 v[196:199], v6 offset:20480
  s_mov_b32 s77, 145408
  buffer_load_dwordx4 v[136:139], v42, s[16:19], s77 offen sc1
  buffer_load_dwordx4 v[140:143], v42, s[16:19], s77 offen offset:1024 sc1
  s_waitcnt lgkmcnt(3)
  v_mfma_f32_32x32x16_bf16 v[208:223], v[164:167], v[184:187], v[208:223]
  ds_read_b128 v[200:203], v7 offset:16384
  s_add_u32 s77, s100, 896
  s_add_u32 m0, s89, 49152
  s_nop 0
  buffer_load_dwordx4 v44, s[24:27], s77 offen lds
  s_add_u32 s77, s100, 9088
  s_add_u32 m0, s89, 50176
  s_nop 0
  buffer_load_dwordx4 v45, s[24:27], s77 offen lds
  s_waitcnt lgkmcnt(3)
  v_mfma_f32_32x32x16_bf16 v[224:239], v[164:167], v[188:191], v[224:239]
  ds_read_b128 v[204:207], v7 offset:20480
  s_waitcnt vmcnt(14)
  v_cmp_ne_u32 vcc, s75, v244
  s_mov_b64 s[94:95], vcc
  v_cmp_ne_u32 vcc, s75, v245
  s_or_b64 s[94:95], s[94:95], vcc
  s_cmp_eq_u64 s[94:95], 0
  s_cbranch_scc1 PFD_42
  s_lshr_b32 s76, s87, 1
  s_lshl_b32 s76, s76, 11
  s_add_u32 s76, s76, 11534848
  v_lshlrev_b32 v17, 3, v1
  s_mov_b32 s91, 0
  buffer_load_dwordx2 v[248:249], v17, s[16:19], s76 offen sc1
  s_sleep 2
  buffer_load_dwordx2 v[250:251], v17, s[16:19], s76 offen sc1
  s_sleep 2
  buffer_load_dwordx2 v[252:253], v17, s[16:19], s76 offen sc1
  s_sleep 2
PF_40:
  s_waitcnt vmcnt(2)
  v_cmp_ne_u32 vcc, s75, v248
  s_add_u32 s91, s91, 1
  s_cbranch_vccnz PFN_43
  v_cmp_ne_u32 vcc, s75, v249
  s_nop 0
  s_cbranch_vccz PFOK_41
PFN_43:
  buffer_load_dwordx2 v[248:249], v17, s[16:19], s76 offen sc1
  s_waitcnt vmcnt(2)
  v_cmp_ne_u32 vcc, s75, v250
  s_add_u32 s91, s91, 1
  s_cbranch_vccnz PFN_44
  v_cmp_ne_u32 vcc, s75, v251
  s_nop 0
  s_cbranch_vccz PFOK_41
PFN_44:
  buffer_load_dwordx2 v[250:251], v17, s[16:19], s76 offen sc1
  s_waitcnt vmcnt(2)
  v_cmp_ne_u32 vcc, s75, v252
  s_add_u32 s91, s91, 1
  s_cbranch_vccnz PFN_45
  v_cmp_ne_u32 vcc, s75, v253
  s_nop 0
  s_cbranch_vccz PFOK_41
PFN_45:
  buffer_load_dwordx2 v[252:253], v17, s[16:19], s76 offen sc1
  s_cmp_gt_u32 s91, 200000
  s_cbranch_scc0 PF_40
PFOK_41:
  s_waitcnt vmcnt(0)
PFD_42:
  s_barrier
  s_waitcnt lgkmcnt(3)
  v_mfma_f32_32x32x16_bf16 v[208:223], v[168:171], v[192:195], v[208:223]
  ds_read_b128 v[176:179], v6 offset:32768
  s_mov_b32 s77, 32768
  buffer_load_dwordx4 v[144:147], v42, s[16:19], s77 offen sc1
  s_waitcnt lgkmcnt(3)
  v_mfma_f32_32x32x16_bf16 v[224:239], v[168:171], v[196:199], v[224:239]
  ds_read_b128 v[180:183], v6 offset:36864
  buffer_load_dwordx4 v[148:151], v42, s[16:19], s77 offen offset:1024 sc1
  s_waitcnt lgkmcnt(3)
  v_mfma_f32_32x32x16_bf16 v[208:223], v[172:175], v[200:203], v[208:223]
  ds_read_b128 v[184:187], v7 offset:32768
  s_add_u32 s77, s98, 32768
  s_add_u32 m0, s89, 65536
  s_nop 0
  buffer_load_dwordx4 v43, s[20:23], s77 offen lds
  s_waitcnt lgkmcnt(3)
  v_mfma_f32_32x32x16_bf16 v[224:239], v[172:175], v[204:207], v[224:239]
  ds_read_b128 v[188:191], v7 offset:36864
  s_add_u32 s77, s98, 40960
  s_add_u32 m0, s89, 66560
  s_nop 0
  buffer_load_dwordx4 v43, s[20:23], s77 offen lds
  s_barrier
  s_waitcnt lgkmcnt(3)
  v_mfma_f32_32x32x16_bf16 v[208:223], v[64:67], v[176:179], v[208:223]
  ds_read_b128 v[192:195], v6 offset:49152
  s_mov_b32 s77, 40960
  buffer_load_dwordx4 v[152:155], v42, s[16:19], s77 offen sc1
  s_waitcnt lgkmcnt(3)
  v_mfma_f32_32x32x16_bf16 v[224:239], v[64:67], v[180:183], v[224:239]
  ds_read_b128 v[196:199], v6 offset:53248
  buffer_load_dwordx4 v[156:159], v42, s[16:19], s77 offen offset:1024 sc1
  s_waitcnt lgkmcnt(3)
  v_mfma_f32_32x32x16_bf16 v[208:223], v[68:71], v[184:187], v[208:223]
  ds_read_b128 v[200:203], v7 offset:49152
  s_add_u32 s77, s98, 425984
  s_add_u32 m0, s89, 81920
  s_nop 0
  buffer_load_dwordx4 v43, s[20:23], s77 offen lds
  s_waitcnt lgkmcnt(3)
  v_mfma_f32_32x32x16_bf16 v[224:239], v[68:71], v[188:191], v[224:239]
  ds_read_b128 v[204:207], v7 offset:53248
  s_add_u32 s77, s98, 434176
  s_add_u32 m0, s89, 82944
  s_nop 0
  buffer_load_dwordx4 v43, s[20:23], s77 offen lds
  s_barrier
  s_waitcnt vmcnt(20)
  s_waitcnt lgkmcnt(3)
  v_mfma_f32_32x32x16_bf16 v[208:223], v[72:75], v[192:195], v[208:223]
  v_xor_b32 v4, 0x10000, v4
  v_xor_b32 v5, 0x10000, v5
  v_xor_b32 v6, 0x10000, v6
  v_xor_b32 v7, 0x10000, v7
  ds_read_b128 v[176:179], v6 offset:0
  s_mov_b32 s77, 49152
  buffer_load_dwordx4 v[160:163], v42, s[16:19], s77 offen sc1
  s_waitcnt lgkmcnt(3)
  v_mfma_f32_32x32x16_bf16 v[224:239], v[72:75], v[196:199], v[224:239]
  ds_read_b128 v[180:183], v6 offset:4096
  buffer_load_dwordx4 v[164:167], v42, s[16:19], s77 offen offset:1024 sc1
  s_waitcnt lgkmcnt(3)
  v_mfma_f32_32x32x16_bf16 v[208:223], v[76:79], v[200:203], v[208:223]
  ds_read_b128 v[184:187], v7 offset:0
  s_add_u32 s77, s98, 819200
  s_add_u32 m0, s89, 98304
  s_nop 0
  buffer_load_dwordx4 v43, s[20:23], s77 offen lds
  s_waitcnt lgkmcnt(3)
  v_mfma_f32_32x32x16_bf16 v[224:239], v[76:79], v[204:207], v[224:239]
  ds_read_b128 v[188:191], v7 offset:4096
  s_add_u32 s77, s98, 827392
  s_add_u32 m0, s89, 99328
  s_nop 0
  buffer_load_dwordx4 v43, s[20:23], s77 offen lds
  s_barrier
  s_waitcnt vmcnt(22)
  s_waitcnt lgkmcnt(3)
  v_mfma_f32_32x32x16_bf16 v[208:223], v[80:83], v[176:179], v[208:223]
  ds_read_b128 v[192:195], v6 offset:16384
  s_mov_b32 s77, 57344
  buffer_load_dwordx4 v[168:171], v42, s[16:19], s77 offen sc1
  s_waitcnt lgkmcnt(3)
  v_mfma_f32_32x32x16_bf16 v[224:239], v[80:83], v[180:183], v[224:239]
  ds_read_b128 v[196:199], v6 offset:20480
  buffer_load_dwordx4 v[172:175], v42, s[16:19], s77 offen offset:1024 sc1
  s_waitcnt lgkmcnt(3)
  v_mfma_f32_32x32x16_bf16 v[208:223], v[84:87], v[184:187], v[208:223]
  ds_read_b128 v[200:203], v7 offset:16384
  s_add_u32 s77, s99, 1179648
  s_add_u32 m0, s89, 114688
  s_nop 0
  buffer_load_dwordx4 v43, s[20:23], s77 offen lds
  s_waitcnt lgkmcnt(3)
  v_mfma_f32_32x32x16_bf16 v[224:239], v[84:87], v[188:191], v[224:239]
  ds_read_b128 v[204:207], v7 offset:20480
  s_add_u32 s77, s99, 1187840
  s_add_u32 m0, s89, 115712
  s_nop 0
  buffer_load_dwordx4 v43, s[20:23], s77 offen lds
  s_waitcnt vmcnt(22)
  s_barrier
  s_waitcnt lgkmcnt(3)
  v_mfma_f32_32x32x16_bf16 v[208:223], v[88:91], v[192:195], v[208:223]
  ds_read_b128 v[176:179], v6 offset:32768
  s_mov_b32 s77, 65536
  buffer_load_dwordx4 v[64:67], v42, s[16:19], s77 offen sc1
  s_waitcnt lgkmcnt(3)
  v_mfma_f32_32x32x16_bf16 v[224:239], v[88:91], v[196:199], v[224:239]
  ds_read_b128 v[180:183], v6 offset:36864
  buffer_load_dwordx4 v[68:71], v42, s[16:19], s77 offen offset:1024 sc1
  s_waitcnt lgkmcnt(3)
  v_mfma_f32_32x32x16_bf16 v[208:223], v[92:95], v[200:203], v[208:223]
  ds_read_b128 v[184:187], v7 offset:32768
  s_add_u32 s77, s98, 65536
  s_add_u32 m0, s89, 0
  s_nop 0
  buffer_load_dwordx4 v43, s[20:23], s77 offen lds
  s_waitcnt lgkmcnt(3)
  v_mfma_f32_32x32x16_bf16 v[224:239], v[92:95], v[204:207], v[224:239]
  ds_read_b128 v[188:191], v7 offset:36864
  s_add_u32 s77, s98, 73728
  s_add_u32 m0, s89, 1024
  s_nop 0
  buffer_load_dwordx4 v43, s[20:23], s77 offen lds
  s_waitcnt vmcnt(20)
  s_barrier
  s_waitcnt lgkmcnt(3)
  v_mfma_f32_32x32x16_bf16 v[208:223], v[128:131], v[176:179], v[208:223]
  ds_read_b128 v[192:195], v6 offset:49152
  s_mov_b32 s77, 73728
  buffer_load_dwordx4 v[72:75], v42, s[16:19], s77 offen sc1
  s_waitcnt lgkmcnt(3)
  v_mfma_f32_32x32x16_bf16 v[224:239], v[128:131], v[180:183], v[224:239]
  ds_read_b128 v[196:199], v6 offset:53248
  buffer_load_dwordx4 v[76:79], v42, s[16:19], s77 offen offset:1024 sc1
  s_waitcnt lgkmcnt(3)
  v_mfma_f32_32x32x16_bf16 v[208:223], v[132:135], v[184:187], v[208:223]
  ds_read_b128 v[200:203], v7 offset:49152
  s_add_u32 s77, s98, 458752
  s_add_u32 m0, s89, 16384
  s_nop 0
  buffer_load_dwordx4 v43, s[20:23], s77 offen lds
  s_waitcnt lgkmcnt(3)
  v_mfma_f32_32x32x16_bf16 v[224:239], v[132:135], v[188:191], v[224:239]
  ds_read_b128 v[204:207], v7 offset:53248
  s_add_u32 s77, s98, 466944
  s_add_u32 m0, s89, 17408
  s_nop 0
  buffer_load_dwordx4 v43, s[20:23], s77 offen lds
  s_waitcnt vmcnt(20)
  s_barrier
  s_waitcnt lgkmcnt(3)
  v_mfma_f32_32x32x16_bf16 v[208:223], v[136:139], v[192:195], v[208:223]
  v_xor_b32 v4, 0x10000, v4
  v_xor_b32 v5, 0x10000, v5
  v_xor_b32 v6, 0x10000, v6
  v_xor_b32 v7, 0x10000, v7
  ds_read_b64_tr_b16 v[176:177], v4 offset:0
  ds_read_b64_tr_b16 v[178:179], v4 offset:1024
  s_mov_b32 s77, 81920
  s_cmp_eq_u32 s37, 3
  s_cselect_b32 s77, 79872, s77
  buffer_load_dwordx4 v[80:83], v42, s[16:19], s77 offen sc1
  s_waitcnt lgkmcnt(4)
  v_mfma_f32_32x32x16_bf16 v[224:239], v[136:139], v[196:199], v[224:239]
  ds_read_b64_tr_b16 v[180:181], v5 offset:0
  ds_read_b64_tr_b16 v[182:183], v5 offset:1024
  buffer_load_dwordx4 v[84:87], v42, s[16:19], s77 offen offset:1024 sc1
  s_waitcnt lgkmcnt(5)
  v_mfma_f32_32x32x16_bf16 v[208:223], v[140:143], v[200:203], v[208:223]
  ds_read_b64_tr_b16 v[184:185], v4 offset:2048
  ds_read_b64_tr_b16 v[186:187], v4 offset:3072
  s_add_u32 s77, s96, 851968
  s_add_u32 m0, s89, 32768
  s_nop 0
  buffer_load_dwordx4 v43, s[20:23], s77 offen lds
  s_waitcnt lgkmcnt(6)
  v_mfma_f32_32x32x16_bf16 v[224:239], v[140:143], v[204:207], v[224:239]
  ds_read_b64_tr_b16 v[188:189], v5 offset:2048
  ds_read_b64_tr_b16 v[190:191], v5 offset:3072
  s_add_u32 s77, s96, 860160
  s_add_u32 m0, s89, 33792
  s_nop 0
  buffer_load_dwordx4 v43, s[20:23], s77 offen lds
  s_waitcnt vmcnt(20)
  s_barrier
  s_waitcnt lgkmcnt(6)
  v_mfma_f32_32x32x16_bf16 v[208:223], v[144:147], v[176:179], v[208:223]
  ds_read_b64_tr_b16 v[192:193], v4 offset:16384
  ds_read_b64_tr_b16 v[194:195], v4 offset:17408
  s_waitcnt lgkmcnt(6)
  v_mfma_f32_32x32x16_bf16 v[224:239], v[144:147], v[180:183], v[224:239]
  ds_read_b64_tr_b16 v[196:197], v5 offset:16384
  ds_read_b64_tr_b16 v[198:199], v5 offset:17408
  s_waitcnt lgkmcnt(6)
  v_mfma_f32_32x32x16_bf16 v[208:223], v[148:151], v[184:187], v[208:223]
  ds_read_b64_tr_b16 v[200:201], v4 offset:18432
  ds_read_b64_tr_b16 v[202:203], v4 offset:19456
  s_waitcnt lgkmcnt(6)
  v_mfma_f32_32x32x16_bf16 v[224:239], v[148:151], v[188:191], v[224:239]
  ds_read_b64_tr_b16 v[204:205], v5 offset:18432
  ds_read_b64_tr_b16 v[206:207], v5 offset:19456
  s_waitcnt vmcnt(16)
  s_barrier
  s_waitcnt lgkmcnt(6)
  v_mfma_f32_32x32x16_bf16 v[208:223], v[152:155], v[192:195], v[208:223]
  ds_read_b64_tr_b16 v[176:177], v4 offset:32768
  ds_read_b64_tr_b16 v[178:179], v4 offset:33792
  s_waitcnt lgkmcnt(6)
  v_mfma_f32_32x32x16_bf16 v[224:239], v[152:155], v[196:199], v[224:239]
  ds_read_b64_tr_b16 v[180:181], v5 offset:32768
  ds_read_b64_tr_b16 v[182:183], v5 offset:33792
  s_waitcnt lgkmcnt(6)
  v_mfma_f32_32x32x16_bf16 v[208:223], v[156:159], v[200:203], v[208:223]
  ds_read_b64_tr_b16 v[184:185], v4 offset:34816
  ds_read_b64_tr_b16 v[186:187], v4 offset:35840
  s_waitcnt lgkmcnt(6)
  v_mfma_f32_32x32x16_bf16 v[224:239], v[156:159], v[204:207], v[224:239]
  ds_read_b64_tr_b16 v[188:189], v5 offset:34816
  ds_read_b64_tr_b16 v[190:191], v5 offset:35840
  v_lshlrev_b32 v8, 16, v8
  v_lshlrev_b32 v10, 16, v10
  v_lshlrev_b32 v9, 1, v9
  v_rcp_f32 v116, v116
  v_rcp_f32 v117, v117
  v_rcp_f32 v118, v118
  v_rcp_f32 v119, v119
  v_lshlrev_b32 v104, 16, v104
  v_lshlrev_b32 v105, 16, v105
  v_lshlrev_b32 v106, 16, v106
  v_lshlrev_b32 v107, 16, v107
  v_lshlrev_b32 v108, 16, v108
  v_lshlrev_b32 v109, 16, v109
  v_lshlrev_b32 v110, 16, v110
  v_lshlrev_b32 v111, 16, v111
  v_sub_f32 v120, v104, v112
  v_sub_f32 v121, v105, v113
  v_sub_f32 v122, v106, v114
  v_sub_f32 v123, v107, v115
  v_sub_f32 v124, v108, v112
  v_sub_f32 v125, v109, v113
  v_sub_f32 v126, v110, v114
  v_sub_f32 v127, v111, v115
  v_cvt_pk_bf16_f32 v18, v120, v121
  v_lshlrev_b32 v120, 16, v18
  v_and_b32 v121, 0xffff0000, v18
  v_cvt_pk_bf16_f32 v18, v122, v123
  v_lshlrev_b32 v122, 16, v18
  v_and_b32 v123, 0xffff0000, v18
  v_cvt_pk_bf16_f32 v18, v124, v125
  v_lshlrev_b32 v124, 16, v18
  v_and_b32 v125, 0xffff0000, v18
  v_cvt_pk_bf16_f32 v18, v126, v127
  v_lshlrev_b32 v126, 16, v18
  v_and_b32 v127, 0xffff0000, v18
  v_mul_f32 v120, v120, v116
  v_mul_f32 v121, v121, v117
  v_mul_f32 v122, v122, v118
  v_mul_f32 v123, v123, v119
  v_mul_f32 v124, v124, v116
  v_mul_f32 v125, v125, v117
  v_mul_f32 v126, v126, v118
  v_mul_f32 v127, v127, v119
  v_cvt_pk_bf16_f32 v18, v120, v121
  v_lshlrev_b32 v120, 16, v18
  v_and_b32 v121, 0xffff0000, v18
  v_cvt_pk_bf16_f32 v18, v122, v123
  v_lshlrev_b32 v122, 16, v18
  v_and_b32 v123, 0xffff0000, v18
  v_cvt_pk_bf16_f32 v18, v124, v125
  v_lshlrev_b32 v124, 16, v18
  v_and_b32 v125, 0xffff0000, v18
  v_cvt_pk_bf16_f32 v18, v126, v127
  v_lshlrev_b32 v126, 16, v18
  v_and_b32 v127, 0xffff0000, v18
  v_mul_f32 v120, v120, v8
  v_mul_f32 v121, v121, v8
  v_mul_f32 v122, v122, v8
  v_mul_f32 v123, v123, v8
  v_mul_f32 v124, v124, v10
  v_mul_f32 v125, v125, v10
  v_mul_f32 v126, v126, v10
  v_mul_f32 v127, v127, v10
  v_cvt_pk_bf16_f32 v18, v120, v121
  v_lshlrev_b32 v120, 16, v18
  v_and_b32 v121, 0xffff0000, v18
  v_cvt_pk_bf16_f32 v18, v122, v123
  v_lshlrev_b32 v122, 16, v18
  v_and_b32 v123, 0xffff0000, v18
  v_cvt_pk_bf16_f32 v18, v124, v125
  v_lshlrev_b32 v124, 16, v18
  v_and_b32 v125, 0xffff0000, v18
  v_cvt_pk_bf16_f32 v18, v126, v127
  v_lshlrev_b32 v126, 16, v18
  v_and_b32 v127, 0xffff0000, v18
  v_add_f32 v120, v120, v104
  v_add_f32 v121, v121, v105
  v_add_f32 v122, v122, v106
  v_add_f32 v123, v123, v107
  v_add_f32 v124, v124, v108
  v_add_f32 v125, v125, v109
  v_add_f32 v126, v126, v110
  v_add_f32 v127, v127, v111
  s_waitcnt vmcnt(12)
  s_barrier
  s_waitcnt lgkmcnt(6)
  v_mfma_f32_32x32x16_bf16 v[208:223], v[160:163], v[176:179], v[208:223]
  ds_read_b64_tr_b16 v[192:193], v4 offset:49152
  ds_read_b64_tr_b16 v[194:195], v4 offset:50176
  s_waitcnt lgkmcnt(6)
  v_mfma_f32_32x32x16_bf16 v[224:239], v[160:163], v[180:183], v[224:239]
  ds_read_b64_tr_b16 v[196:197], v5 offset:49152
  ds_read_b64_tr_b16 v[198:199], v5 offset:50176
  s_waitcnt lgkmcnt(6)
  v_mfma_f32_32x32x16_bf16 v[208:223], v[164:167], v[184:187], v[208:223]
  ds_read_b64_tr_b16 v[200:201], v4 offset:51200
  ds_read_b64_tr_b16 v[202:203], v4 offset:52224
  s_waitcnt lgkmcnt(6)
  v_mfma_f32_32x32x16_bf16 v[224:239], v[164:167], v[188:191], v[224:239]
  ds_read_b64_tr_b16 v[204:205], v5 offset:51200
  ds_read_b64_tr_b16 v[206:207], v5 offset:52224
  s_waitcnt vmcnt(8)
  s_barrier
  s_waitcnt lgkmcnt(6)
  v_mfma_f32_32x32x16_bf16 v[208:223], v[168:171], v[192:195], v[208:223]
  v_xor_b32 v4, 0x10000, v4
  v_xor_b32 v5, 0x10000, v5
  v_xor_b32 v6, 0x10000, v6
  v_xor_b32 v7, 0x10000, v7
  ds_read_b64_tr_b16 v[176:177], v4 offset:0
  ds_read_b64_tr_b16 v[178:179], v4 offset:1024
  s_waitcnt lgkmcnt(6)
  v_mfma_f32_32x32x16_bf16 v[224:239], v[168:171], v[196:199], v[224:239]
  ds_read_b64_tr_b16 v[180:181], v5 offset:0
  ds_read_b64_tr_b16 v[182:183], v5 offset:1024
  s_waitcnt lgkmcnt(6)
  v_mfma_f32_32x32x16_bf16 v[208:223], v[172:175], v[200:203], v[208:223]
  ds_read_b64_tr_b16 v[184:185], v4 offset:2048
  ds_read_b64_tr_b16 v[186:187], v4 offset:3072
  s_waitcnt lgkmcnt(6)
  v_mfma_f32_32x32x16_bf16 v[224:239], v[172:175], v[204:207], v[224:239]
  ds_read_b64_tr_b16 v[188:189], v5 offset:2048
  ds_read_b64_tr_b16 v[190:191], v5 offset:3072
  s_waitcnt vmcnt(4)
  s_barrier
  s_waitcnt lgkmcnt(6)
  v_mfma_f32_32x32x16_bf16 v[208:223], v[64:67], v[176:179], v[208:223]
  ds_read_b64_tr_b16 v[192:193], v4 offset:16384
  ds_read_b64_tr_b16 v[194:195], v4 offset:17408
  s_waitcnt lgkmcnt(6)
  v_mfma_f32_32x32x16_bf16 v[224:239], v[64:67], v[180:183], v[224:239]
  ds_read_b64_tr_b16 v[196:197], v5 offset:16384
  ds_read_b64_tr_b16 v[198:199], v5 offset:17408
  s_waitcnt lgkmcnt(6)
  v_mfma_f32_32x32x16_bf16 v[208:223], v[68:71], v[184:187], v[208:223]
  ds_read_b64_tr_b16 v[200:201], v4 offset:18432
  ds_read_b64_tr_b16 v[202:203], v4 offset:19456
  s_waitcnt lgkmcnt(6)
  v_mfma_f32_32x32x16_bf16 v[224:239], v[68:71], v[188:191], v[224:239]
  ds_read_b64_tr_b16 v[204:205], v5 offset:18432
  ds_read_b64_tr_b16 v[206:207], v5 offset:19456
  s_waitcnt vmcnt(0)
  s_barrier
  s_waitcnt lgkmcnt(6)
  v_mfma_f32_32x32x16_bf16 v[208:223], v[72:75], v[192:195], v[208:223]
  ds_read_b64_tr_b16 v[176:177], v4 offset:32768
  ds_read_b64_tr_b16 v[178:179], v4 offset:33792
  s_waitcnt lgkmcnt(6)
  v_mfma_f32_32x32x16_bf16 v[224:239], v[72:75], v[196:199], v[224:239]
  ds_read_b64_tr_b16 v[180:181], v5 offset:32768
  ds_read_b64_tr_b16 v[182:183], v5 offset:33792
  s_waitcnt lgkmcnt(6)
  v_mfma_f32_32x32x16_bf16 v[208:223], v[76:79], v[200:203], v[208:223]
  ds_read_b64_tr_b16 v[184:185], v4 offset:34816
  ds_read_b64_tr_b16 v[186:187], v4 offset:35840
  s_waitcnt lgkmcnt(6)
  v_mfma_f32_32x32x16_bf16 v[224:239], v[76:79], v[204:207], v[224:239]
  ds_read_b64_tr_b16 v[188:189], v5 offset:34816
  ds_read_b64_tr_b16 v[190:191], v5 offset:35840
  s_waitcnt lgkmcnt(6)
  v_mfma_f32_32x32x16_bf16 v[208:223], v[80:83], v[176:179], v[208:223]
  s_waitcnt lgkmcnt(4)
  v_mfma_f32_32x32x16_bf16 v[224:239], v[80:83], v[180:183], v[224:239]
  s_waitcnt lgkmcnt(2)
  v_mfma_f32_32x32x16_bf16 v[208:223], v[84:87], v[184:187], v[208:223]
  s_waitcnt lgkmcnt(0)
  v_mfma_f32_32x32x16_bf16 v[224:239], v[84:87], v[188:191], v[224:239]
  s_nop 15
  s_barrier
  s_lshl_b32 s76, s37, 11
  v_lshlrev_b32 v17, 4, v1
  v_add_u32 v18, s76, v17
  v_add_u32 v18, 0, v18
  ds_write_b128 v18, v[208:211] offset:0
  ds_write_b128 v18, v[224:227] offset:1024
  ds_write_b128 v18, v[212:215] offset:8192
  ds_write_b128 v18, v[228:231] offset:9216
  ds_write_b128 v18, v[216:219] offset:16384
  ds_write_b128 v18, v[232:235] offset:17408
  ds_write_b128 v18, v[220:223] offset:24576
  ds_write_b128 v18, v[236:239] offset:25600
  s_lshl_b32 s76, s37, 13
  v_add_u32 v18, s76, v17
  v_add_u32 v18, 0, v18
  s_waitcnt lgkmcnt(0)
  s_barrier
  ds_read_b128 v[128:131], v18 offset:0
  ds_read_b128 v[132:135], v18 offset:1024
  ds_read_b128 v[136:139], v18 offset:2048
  ds_read_b128 v[140:143], v18 offset:3072
  ds_read_b128 v[144:147], v18 offset:4096
  ds_read_b128 v[148:151], v18 offset:5120
  ds_read_b128 v[152:155], v18 offset:6144
  ds_read_b128 v[156:159], v18 offset:7168
  s_waitcnt lgkmcnt(0)
  v_add_f32 v128, v128, v136
  v_add_f32 v144, v144, v152
  v_add_f32 v129, v129, v137
  v_add_f32 v145, v145, v153
  v_add_f32 v130, v130, v138
  v_add_f32 v146, v146, v154
  v_add_f32 v131, v131, v139
  v_add_f32 v147, v147, v155
  v_add_f32 v132, v132, v140
  v_add_f32 v148, v148, v156
  v_add_f32 v133, v133, v141
  v_add_f32 v149, v149, v157
  v_add_f32 v134, v134, v142
  v_add_f32 v150, v150, v158
  v_add_f32 v135, v135, v143
  v_add_f32 v151, v151, v159
  v_add_f32 v128, v128, v144
  v_add_f32 v129, v129, v145
  v_add_f32 v130, v130, v146
  v_add_f32 v131, v131, v147
  v_add_f32 v132, v132, v148
  v_add_f32 v133, v133, v149
  v_add_f32 v134, v134, v150
  v_add_f32 v135, v135, v151
  v_add_f32 v128, v128, v120
  v_add_f32 v129, v129, v121
  v_add_f32 v130, v130, v122
  v_add_f32 v131, v131, v123
  v_add_f32 v132, v132, v124
  v_add_f32 v133, v133, v125
  v_add_f32 v134, v134, v126
  v_add_f32 v135, v135, v127
  s_mov_b32 s76, 0
  buffer_store_dword v128, v9, s[28:31], s76 offen offset:0 sc0 sc1
  s_mov_b32 s76, 0
  buffer_store_dword v129, v9, s[28:31], s76 offen offset:2048 sc0 sc1
  s_mov_b32 s76, 4096
  buffer_store_dword v130, v9, s[28:31], s76 offen offset:0 sc0 sc1
  s_mov_b32 s76, 4096
  buffer_store_dword v131, v9, s[28:31], s76 offen offset:2048 sc0 sc1
  s_mov_b32 s76, 0
  buffer_store_dword v132, v9, s[28:31], s76 offen offset:128 sc0 sc1
  s_mov_b32 s76, 0
  buffer_store_dword v133, v9, s[28:31], s76 offen offset:2176 sc0 sc1
  s_mov_b32 s76, 4096
  buffer_store_dword v134, v9, s[28:31], s76 offen offset:128 sc0 sc1
  s_mov_b32 s76, 4096
  buffer_store_dword v135, v9, s[28:31], s76 offen offset:2176 sc0 sc1
  s_cmp_eq_u32 s87, 31
  s_cbranch_scc0 EP_46
  s_cmp_eq_u32 s88, 0
  s_cbranch_scc0 EP_46
  s_cmp_eq_u32 s36, 0
  s_cbranch_scc0 EP_46
  v_mov_b32 v4, s75
  v_mov_b32 v3, 0
  s_mov_b32 s76, 11599872
  s_mov_b64 exec, 1
  buffer_store_dword v4, v3, s[16:19], s76 offen sc1
  s_mov_b64 exec, -1
EP_46:
  s_endpgm
L_STREAM_B:
  s_waitcnt lgkmcnt(0)
  s_add_u32 s75, s75, 1
  v_add_u32 v8, 24576, v0
  s_lshr_b32 s86, s38, 3
  s_add_u32 s86, s86, 1
  s_cmp_eq_u32 s37, 0
  s_cselect_b32 s86, s86, 0
  v_mov_b32 v28, 0x3f803f80
  v_mov_b32 v29, 0x3f803f80
  v_mov_b32 v30, 0x3f803f80
  v_mov_b32 v31, 0x3f803f80
  v_mov_b32 v64, 0
  v_mov_b32 v65, 0
  v_mov_b32 v66, 0
  v_mov_b32 v67, 0
  v_mov_b32 v68, 0
  v_mov_b32 v69, 0
  v_mov_b32 v70, 0
  v_mov_b32 v71, 0
  v_mov_b32 v72, 0
  v_mov_b32 v73, 0
  v_mov_b32 v74, 0
  v_mov_b32 v75, 0
  v_mov_b32 v76, 0
  v_mov_b32 v77, 0
  v_mov_b32 v78, 0
  v_mov_b32 v79, 0
  v_mov_b32 v80, 0
  v_mov_b32 v81, 0
  v_mov_b32 v82, 0
  v_mov_b32 v83, 0
  v_mov_b32 v84, 0
  v_mov_b32 v85, 0
  v_mov_b32 v86, 0
  v_mov_b32 v87, 0
  v_mov_b32 v88, 0
  v_mov_b32 v89, 0
  v_mov_b32 v90, 0
  v_mov_b32 v91, 0
  v_mov_b32 v92, 0
  v_mov_b32 v93, 0
  v_mov_b32 v94, 0
  v_mov_b32 v95, 0
  v_mov_b32 v96, 0
  v_mov_b32 v97, 0
  v_mov_b32 v98, 0
  v_mov_b32 v99, 0
  v_mov_b32 v100, 0
  v_mov_b32 v101, 0
  v_mov_b32 v102, 0
  v_mov_b32 v103, 0
  v_mov_b32 v104, 0
  v_mov_b32 v105, 0
  v_mov_b32 v106, 0
  v_mov_b32 v107, 0
  v_mov_b32 v108, 0
  v_mov_b32 v109, 0
  v_mov_b32 v110, 0
  v_mov_b32 v111, 0
  v_mov_b32 v112, 0
  v_mov_b32 v113, 0
  v_mov_b32 v114, 0
  v_mov_b32 v115, 0
  v_mov_b32 v116, 0
  v_mov_b32 v117, 0
  v_mov_b32 v118, 0
  v_mov_b32 v119, 0
  v_mov_b32 v120, 0
  v_mov_b32 v121, 0
  v_mov_b32 v122, 0
  v_mov_b32 v123, 0
  v_mov_b32 v124, 0
  v_mov_b32 v125, 0
  v_mov_b32 v126, 0
  v_mov_b32 v127, 0
  s_waitcnt vmcnt(7)
  s_barrier
  ds_read_b128 v[128:131], v4 offset:0
  ds_read_b128 v[132:135], v5 offset:0
  ds_read_b128 v[136:139], v6 offset:0
  ds_read_b128 v[140:143], v7 offset:0
  ds_read_b64_tr_b16 v[48:49], v8 offset:0
  ds_read_b64_tr_b16 v[50:51], v8 offset:256
  ds_read_b64_tr_b16 v[52:53], v8 offset:4096
  ds_read_b64_tr_b16 v[54:55], v8 offset:4352
  ds_read_b64_tr_b16 v[56:57], v8 offset:1024
  ds_read_b64_tr_b16 v[58:59], v8 offset:1280
  s_waitcnt lgkmcnt(9)
  s_waitcnt lgkmcnt(4)
  v_mfma_f32_32x32x16_bf16 v[64:79], v[48:51], v[128:131], v[64:79]
  s_cmp_eq_u32 s86, 1
  s_cbranch_scc0 CSK_47
  v_mfma_f32_32x32x16_bf16 v[96:111], v[28:31], v[48:51], 0
CSK_47:
  ds_read_b64_tr_b16 v[60:61], v8 offset:5120
  ds_read_b64_tr_b16 v[62:63], v8 offset:5376
  s_add_u32 s76, s72, 2
  s_and_b32 s76, s76, 7
  s_lshl_b32 s79, s76, 7
  s_add_u32 s80, s79, 16384
  s_add_u32 m0, s97, 65536
  s_nop 0
  buffer_load_dwordx4 v13, s[4:7], s79 offen lds
  s_waitcnt lgkmcnt(4)
  v_mfma_f32_32x32x16_bf16 v[80:95], v[52:55], v[128:131], v[80:95]
  s_cmp_eq_u32 s86, 2
  s_cbranch_scc0 CSK_48
  v_mfma_f32_32x32x16_bf16 v[96:111], v[28:31], v[52:55], 0
CSK_48:
  ds_read_b64_tr_b16 v[48:49], v8 offset:2048
  ds_read_b64_tr_b16 v[50:51], v8 offset:2304
  s_waitcnt lgkmcnt(4)
  v_mfma_f32_32x32x16_bf16 v[64:79], v[56:59], v[132:135], v[64:79]
  s_cmp_eq_u32 s86, 1
  s_cbranch_scc0 CSK_49
  v_mfma_f32_32x32x16_bf16 v[96:111], v[28:31], v[56:59], v[96:111]
CSK_49:
  ds_read_b64_tr_b16 v[52:53], v8 offset:6144
  ds_read_b64_tr_b16 v[54:55], v8 offset:6400
  s_add_u32 m0, s97, 66560
  s_nop 0
  buffer_load_dwordx4 v14, s[4:7], s79 offen lds
  s_waitcnt lgkmcnt(4)
  v_mfma_f32_32x32x16_bf16 v[80:95], v[60:63], v[132:135], v[80:95]
  s_cmp_eq_u32 s86, 2
  s_cbranch_scc0 CSK_50
  v_mfma_f32_32x32x16_bf16 v[96:111], v[28:31], v[60:63], v[96:111]
CSK_50:
  ds_read_b64_tr_b16 v[56:57], v8 offset:3072
  ds_read_b64_tr_b16 v[58:59], v8 offset:3328
  s_waitcnt lgkmcnt(4)
  v_mfma_f32_32x32x16_bf16 v[64:79], v[48:51], v[136:139], v[64:79]
  s_cmp_eq_u32 s86, 1
  s_cbranch_scc0 CSK_51
  v_mfma_f32_32x32x16_bf16 v[96:111], v[28:31], v[48:51], v[96:111]
CSK_51:
  ds_read_b64_tr_b16 v[60:61], v8 offset:7168
  ds_read_b64_tr_b16 v[62:63], v8 offset:7424
  s_add_u32 m0, s97, 67584
  s_nop 0
  buffer_load_dwordx4 v13, s[4:7], s80 offen lds
  s_waitcnt lgkmcnt(4)
  v_mfma_f32_32x32x16_bf16 v[80:95], v[52:55], v[136:139], v[80:95]
  s_cmp_eq_u32 s86, 2
  s_cbranch_scc0 CSK_52
  v_mfma_f32_32x32x16_bf16 v[96:111], v[28:31], v[52:55], v[96:111]
CSK_52:
  s_waitcnt vmcnt(6)
  s_barrier
  ds_read_b128 v[144:147], v4 offset:32768
  ds_read_b128 v[148:151], v5 offset:32768
  ds_read_b128 v[152:155], v6 offset:32768
  ds_read_b128 v[156:159], v7 offset:32768
  ds_read_b64_tr_b16 v[48:49], v8 offset:32768
  ds_read_b64_tr_b16 v[50:51], v8 offset:33024
  s_add_u32 m0, s97, 68608
  s_nop 0
  buffer_load_dwordx4 v14, s[4:7], s80 offen lds
  s_add_u32 s76, s72, 3
  s_and_b32 s76, s76, 7
  s_lshl_b32 s79, s76, 7
  s_add_u32 s80, s79, 16384
  s_add_u32 m0, s97, 98304
  s_nop 0
  buffer_load_dwordx4 v13, s[4:7], s79 offen lds
  s_waitcnt lgkmcnt(8)
  v_mfma_f32_32x32x16_bf16 v[64:79], v[56:59], v[140:143], v[64:79]
  s_cmp_eq_u32 s86, 1
  s_cbranch_scc0 CSK_53
  v_mfma_f32_32x32x16_bf16 v[96:111], v[28:31], v[56:59], v[96:111]
CSK_53:
  ds_read_b64_tr_b16 v[52:53], v8 offset:36864
  ds_read_b64_tr_b16 v[54:55], v8 offset:37120
  s_add_u32 m0, s97, 99328
  s_nop 0
  buffer_load_dwordx4 v14, s[4:7], s79 offen lds
  s_waitcnt lgkmcnt(8)
  v_mfma_f32_32x32x16_bf16 v[80:95], v[60:63], v[140:143], v[80:95]
  s_cmp_eq_u32 s86, 2
  s_cbranch_scc0 CSK_54
  v_mfma_f32_32x32x16_bf16 v[96:111], v[28:31], v[60:63], v[96:111]
CSK_54:
  ds_read_b64_tr_b16 v[56:57], v8 offset:33792
  ds_read_b64_tr_b16 v[58:59], v8 offset:34048
  s_nop 7
  s_nop 7
  s_add_u32 s77, s72, 0
  s_and_b32 s77, s77, 7
  s_lshl_b32 s76, s39, 3
  s_add_u32 s76, s76, s77
  s_lshl_b32 s76, s76, 11
  s_sub_u32 s77, s86, 1
  s_lshl_b32 s77, s77, 8
  s_add_u32 s76, s76, s77
  s_add_u32 s76, s76, 11010560
  s_lshl_b32 s77, s2, 11
  s_add_u32 s77, s77, 11665408
  s_cmp_eq_u32 s86, 0
  s_cselect_b32 s76, s77, s76
  v_mov_b32 v97, s75
  v_lshlrev_b32 v98, 3, v1
  s_mov_b64 s[92:93], exec
  s_mov_b64 exec, 0xffffffff
  buffer_store_dwordx2 v[96:97], v98, s[16:19], s76 offen sc1
  s_mov_b64 exec, s[92:93]
  s_nop 7
  v_mov_b32 v96, 0
  v_mov_b32 v97, 0
  v_mov_b32 v98, 0
  v_mov_b32 v99, 0
  v_mov_b32 v100, 0
  v_mov_b32 v101, 0
  v_mov_b32 v102, 0
  v_mov_b32 v103, 0
  v_mov_b32 v104, 0
  v_mov_b32 v105, 0
  v_mov_b32 v106, 0
  v_mov_b32 v107, 0
  v_mov_b32 v108, 0
  v_mov_b32 v109, 0
  v_mov_b32 v110, 0
  v_mov_b32 v111, 0
  s_waitcnt lgkmcnt(9)
  s_waitcnt lgkmcnt(4)
  v_mfma_f32_32x32x16_bf16 v[64:79], v[48:51], v[144:147], v[64:79]
  ds_read_b64_tr_b16 v[60:61], v8 offset:37888
  ds_read_b64_tr_b16 v[62:63], v8 offset:38144
  s_add_u32 m0, s97, 100352
  s_nop 0
  buffer_load_dwordx4 v13, s[4:7], s80 offen lds
  s_waitcnt lgkmcnt(4)
  v_mfma_f32_32x32x16_bf16 v[80:95], v[52:55], v[144:147], v[80:95]
  ds_read_b64_tr_b16 v[48:49], v8 offset:34816
  ds_read_b64_tr_b16 v[50:51], v8 offset:35072
  s_waitcnt lgkmcnt(4)
  v_mfma_f32_32x32x16_bf16 v[64:79], v[56:59], v[148:151], v[64:79]
  ds_read_b64_tr_b16 v[52:53], v8 offset:38912
  ds_read_b64_tr_b16 v[54:55], v8 offset:39168
  s_add_u32 m0, s97, 101376
  s_nop 0
  buffer_load_dwordx4 v14, s[4:7], s80 offen lds
  s_waitcnt lgkmcnt(4)
  v_mfma_f32_32x32x16_bf16 v[80:95], v[60:63], v[148:151], v[80:95]
  ds_read_b64_tr_b16 v[56:57], v8 offset:35840
  ds_read_b64_tr_b16 v[58:59], v8 offset:36096
  s_waitcnt lgkmcnt(4)
  v_mfma_f32_32x32x16_bf16 v[64:79], v[48:51], v[152:155], v[64:79]
  ds_read_b64_tr_b16 v[60:61], v8 offset:39936
  ds_read_b64_tr_b16 v[62:63], v8 offset:40192
  s_waitcnt lgkmcnt(4)
  v_mfma_f32_32x32x16_bf16 v[80:95], v[52:55], v[152:155], v[80:95]
  s_waitcnt vmcnt(5)
  s_barrier
  v_xor_b32 v4, 0x10000, v4
  v_xor_b32 v5, 0x10000, v5
  v_xor_b32 v6, 0x10000, v6
  v_xor_b32 v7, 0x10000, v7
  v_xor_b32 v8, 0x10000, v8
  ds_read_b128 v[160:163], v4 offset:0
  ds_read_b128 v[164:167], v5 offset:0
  ds_read_b128 v[168:171], v6 offset:0
  ds_read_b128 v[172:175], v7 offset:0
  ds_read_b64_tr_b16 v[48:49], v8 offset:0
  ds_read_b64_tr_b16 v[50:51], v8 offset:256
  s_waitcnt lgkmcnt(8)
  v_mfma_f32_32x32x16_bf16 v[64:79], v[56:59], v[156:159], v[64:79]
  ds_read_b64_tr_b16 v[52:53], v8 offset:4096
  ds_read_b64_tr_b16 v[54:55], v8 offset:4352
  s_add_u32 s76, s72, 4
  s_and_b32 s76, s76, 7
  s_lshl_b32 s79, s76, 7
  s_add_u32 s80, s79, 16384
  s_add_u32 m0, s97, 0
  s_nop 0
  buffer_load_dwordx4 v13, s[4:7], s79 offen lds
  s_waitcnt lgkmcnt(8)
  v_mfma_f32_32x32x16_bf16 v[80:95], v[60:63], v[156:159], v[80:95]
  ds_read_b64_tr_b16 v[56:57], v8 offset:1024
  ds_read_b64_tr_b16 v[58:59], v8 offset:1280
  s_waitcnt lgkmcnt(9)
  s_waitcnt lgkmcnt(4)
  v_mfma_f32_32x32x16_bf16 v[64:79], v[48:51], v[160:163], v[64:79]
  ds_read_b64_tr_b16 v[60:61], v8 offset:5120
  ds_read_b64_tr_b16 v[62:63], v8 offset:5376
  s_add_u32 m0, s97, 1024
  s_nop 0
  buffer_load_dwordx4 v14, s[4:7], s79 offen lds
  s_waitcnt lgkmcnt(4)
  v_mfma_f32_32x32x16_bf16 v[80:95], v[52:55], v[160:163], v[80:95]
  ds_read_b64_tr_b16 v[48:49], v8 offset:2048
  ds_read_b64_tr_b16 v[50:51], v8 offset:2304
  s_waitcnt lgkmcnt(4)
  v_mfma_f32_32x32x16_bf16 v[64:79], v[56:59], v[164:167], v[64:79]
  ds_read_b64_tr_b16 v[52:53], v8 offset:6144
  ds_read_b64_tr_b16 v[54:55], v8 offset:6400
  s_add_u32 m0, s97, 2048
  s_nop 0
  buffer_load_dwordx4 v13, s[4:7], s80 offen lds
  s_waitcnt lgkmcnt(4)
  v_mfma_f32_32x32x16_bf16 v[80:95], v[60:63], v[164:167], v[80:95]
  ds_read_b64_tr_b16 v[56:57], v8 offset:3072
  ds_read_b64_tr_b16 v[58:59], v8 offset:3328
  s_waitcnt lgkmcnt(4)
  v_mfma_f32_32x32x16_bf16 v[64:79], v[48:51], v[168:171], v[64:79]
  ds_read_b64_tr_b16 v[60:61], v8 offset:7168
  ds_read_b64_tr_b16 v[62:63], v8 offset:7424
  s_add_u32 m0, s97, 3072
  s_nop 0
  buffer_load_dwordx4 v14, s[4:7], s80 offen lds
  s_waitcnt lgkmcnt(4)
  v_mfma_f32_32x32x16_bf16 v[80:95], v[52:55], v[168:171], v[80:95]
  s_waitcnt vmcnt(4)
  s_barrier
  ds_read_b128 v[176:179], v4 offset:32768
  ds_read_b128 v[180:183], v5 offset:32768
  ds_read_b128 v[184:187], v6 offset:32768
  ds_read_b128 v[188:191], v7 offset:32768
  ds_read_b64_tr_b16 v[48:49], v8 offset:32768
  ds_read_b64_tr_b16 v[50:51], v8 offset:33024
  s_waitcnt lgkmcnt(8)
  v_mfma_f32_32x32x16_bf16 v[64:79], v[56:59], v[172:175], v[64:79]
  ds_read_b64_tr_b16 v[52:53], v8 offset:36864
  ds_read_b64_tr_b16 v[54:55], v8 offset:37120
  s_add_u32 s76, s72, 5
  s_and_b32 s76, s76, 7
  s_lshl_b32 s79, s76, 7
  s_add_u32 s80, s79, 16384
  s_add_u32 m0, s97, 32768
  s_nop 0
  buffer_load_dwordx4 v13, s[4:7], s79 offen lds
  s_waitcnt lgkmcnt(8)
  v_mfma_f32_32x32x16_bf16 v[80:95], v[60:63], v[172:175], v[80:95]
  ds_read_b64_tr_b16 v[56:57], v8 offset:33792
  ds_read_b64_tr_b16 v[58:59], v8 offset:34048
  s_waitcnt lgkmcnt(9)
  s_waitcnt lgkmcnt(4)
  v_mfma_f32_32x32x16_bf16 v[64:79], v[48:51], v[176:179], v[64:79]
  ds_read_b64_tr_b16 v[60:61], v8 offset:37888
  ds_read_b64_tr_b16 v[62:63], v8 offset:38144
  s_add_u32 m0, s97, 33792
  s_nop 0
  buffer_load_dwordx4 v14, s[4:7], s79 offen lds
  s_waitcnt lgkmcnt(4)
  v_mfma_f32_32x32x16_bf16 v[80:95], v[52:55], v[176:179], v[80:95]
  ds_read_b64_tr_b16 v[48:49], v8 offset:34816
  ds_read_b64_tr_b16 v[50:51], v8 offset:35072
  s_waitcnt lgkmcnt(4)
  v_mfma_f32_32x32x16_bf16 v[64:79], v[56:59], v[180:183], v[64:79]
  ds_read_b64_tr_b16 v[52:53], v8 offset:38912
  ds_read_b64_tr_b16 v[54:55], v8 offset:39168
  s_add_u32 m0, s97, 34816
  s_nop 0
  buffer_load_dwordx4 v13, s[4:7], s80 offen lds
  s_waitcnt lgkmcnt(4)
  v_mfma_f32_32x32x16_bf16 v[80:95], v[60:63], v[180:183], v[80:95]
  ds_read_b64_tr_b16 v[56:57], v8 offset:35840
  ds_read_b64_tr_b16 v[58:59], v8 offset:36096
  s_waitcnt lgkmcnt(4)
  v_mfma_f32_32x32x16_bf16 v[64:79], v[48:51], v[184:187], v[64:79]
  ds_read_b64_tr_b16 v[60:61], v8 offset:39936
  ds_read_b64_tr_b16 v[62:63], v8 offset:40192
  s_add_u32 m0, s97, 35840
  s_nop 0
  buffer_load_dwordx4 v14, s[4:7], s80 offen lds
  s_waitcnt lgkmcnt(4)
  v_mfma_f32_32x32x16_bf16 v[80:95], v[52:55], v[184:187], v[80:95]
  s_waitcnt vmcnt(4)
  s_barrier
  v_xor_b32 v4, 0x10000, v4
  v_xor_b32 v5, 0x10000, v5
  v_xor_b32 v6, 0x10000, v6
  v_xor_b32 v7, 0x10000, v7
  v_xor_b32 v8, 0x10000, v8
  ds_read_b128 v[192:195], v4 offset:0
  ds_read_b128 v[196:199], v5 offset:0
  ds_read_b128 v[200:203], v6 offset:0
  ds_read_b128 v[204:207], v7 offset:0
  ds_read_b64_tr_b16 v[48:49], v8 offset:0
  ds_read_b64_tr_b16 v[50:51], v8 offset:256
  s_waitcnt lgkmcnt(8)
  v_mfma_f32_32x32x16_bf16 v[64:79], v[56:59], v[188:191], v[64:79]
  ds_read_b64_tr_b16 v[52:53], v8 offset:4096
  ds_read_b64_tr_b16 v[54:55], v8 offset:4352
  s_add_u32 s76, s72, 6
  s_and_b32 s76, s76, 7
  s_lshl_b32 s79, s76, 7
  s_add_u32 s80, s79, 16384
  s_add_u32 m0, s97, 65536
  s_nop 0
  buffer_load_dwordx4 v13, s[4:7], s79 offen lds
  s_waitcnt lgkmcnt(8)
  v_mfma_f32_32x32x16_bf16 v[80:95], v[60:63], v[188:191], v[80:95]
  ds_read_b64_tr_b16 v[56:57], v8 offset:1024
  ds_read_b64_tr_b16 v[58:59], v8 offset:1280
  s_waitcnt lgkmcnt(9)
  s_waitcnt lgkmcnt(4)
  v_mfma_f32_32x32x16_bf16 v[64:79], v[48:51], v[192:195], v[64:79]
  ds_read_b64_tr_b16 v[60:61], v8 offset:5120
  ds_read_b64_tr_b16 v[62:63], v8 offset:5376
  s_add_u32 m0, s97, 66560
  s_nop 0
  buffer_load_dwordx4 v14, s[4:7], s79 offen lds
  s_waitcnt lgkmcnt(4)
  v_mfma_f32_32x32x16_bf16 v[80:95], v[52:55], v[192:195], v[80:95]
  ds_read_b64_tr_b16 v[48:49], v8 offset:2048
  ds_read_b64_tr_b16 v[50:51], v8 offset:2304
  s_waitcnt lgkmcnt(4)
  v_mfma_f32_32x32x16_bf16 v[64:79], v[56:59], v[196:199], v[64:79]
  ds_read_b64_tr_b16 v[52:53], v8 offset:6144
  ds_read_b64_tr_b16 v[54:55], v8 offset:6400
  s_add_u32 m0, s97, 67584
  s_nop 0
  buffer_load_dwordx4 v13, s[4:7], s80 offen lds
  s_waitcnt lgkmcnt(4)
  v_mfma_f32_32x32x16_bf16 v[80:95], v[60:63], v[196:199], v[80:95]
  ds_read_b64_tr_b16 v[56:57], v8 offset:3072
  ds_read_b64_tr_b16 v[58:59], v8 offset:3328
  s_waitcnt lgkmcnt(4)
  v_mfma_f32_32x32x16_bf16 v[64:79], v[48:51], v[200:203], v[64:79]
  ds_read_b64_tr_b16 v[60:61], v8 offset:7168
  ds_read_b64_tr_b16 v[62:63], v8 offset:7424
  s_add_u32 m0, s97, 68608
  s_nop 0
  buffer_load_dwordx4 v14, s[4:7], s80 offen lds
  s_waitcnt lgkmcnt(4)
  v_mfma_f32_32x32x16_bf16 v[80:95], v[52:55], v[200:203], v[80:95]
  s_waitcnt vmcnt(4)
  s_barrier
  ds_read_b128 v[208:211], v4 offset:32768
  ds_read_b128 v[212:215], v5 offset:32768
  ds_read_b128 v[216:219], v6 offset:32768
  ds_read_b128 v[220:223], v7 offset:32768
  ds_read_b64_tr_b16 v[48:49], v8 offset:32768
  ds_read_b64_tr_b16 v[50:51], v8 offset:33024
  s_waitcnt lgkmcnt(8)
  v_mfma_f32_32x32x16_bf16 v[64:79], v[56:59], v[204:207], v[64:79]
  ds_read_b64_tr_b16 v[52:53], v8 offset:36864
  ds_read_b64_tr_b16 v[54:55], v8 offset:37120
  s_add_u32 s76, s72, 7
  s_and_b32 s76, s76, 7
  s_lshl_b32 s79, s76, 7
  s_add_u32 s80, s79, 16384
  s_add_u32 m0, s97, 98304
  s_nop 0
  buffer_load_dwordx4 v13, s[4:7], s79 offen lds
  s_waitcnt lgkmcnt(8)
  v_mfma_f32_32x32x16_bf16 v[80:95], v[60:63], v[204:207], v[80:95]
  ds_read_b64_tr_b16 v[56:57], v8 offset:33792
  ds_read_b64_tr_b16 v[58:59], v8 offset:34048
  s_waitcnt lgkmcnt(9)
  s_waitcnt lgkmcnt(4)
  v_mfma_f32_32x32x16_bf16 v[64:79], v[48:51], v[208:211], v[64:79]
  ds_read_b64_tr_b16 v[60:61], v8 offset:37888
  ds_read_b64_tr_b16 v[62:63], v8 offset:38144
  s_add_u32 m0, s97, 99328
  s_nop 0
  buffer_load_dwordx4 v14, s[4:7], s79 offen lds
  s_waitcnt lgkmcnt(4)
  v_mfma_f32_32x32x16_bf16 v[80:95], v[52:55], v[208:211], v[80:95]
  ds_read_b64_tr_b16 v[48:49], v8 offset:34816
  ds_read_b64_tr_b16 v[50:51], v8 offset:35072
  s_waitcnt lgkmcnt(4)
  v_mfma_f32_32x32x16_bf16 v[64:79], v[56:59], v[212:215], v[64:79]
  ds_read_b64_tr_b16 v[52:53], v8 offset:38912
  ds_read_b64_tr_b16 v[54:55], v8 offset:39168
  s_add_u32 m0, s97, 100352
  s_nop 0
  buffer_load_dwordx4 v13, s[4:7], s80 offen lds
  s_waitcnt lgkmcnt(4)
  v_mfma_f32_32x32x16_bf16 v[80:95], v[60:63], v[212:215], v[80:95]
  ds_read_b64_tr_b16 v[56:57], v8 offset:35840
  ds_read_b64_tr_b16 v[58:59], v8 offset:36096
  s_waitcnt lgkmcnt(4)
  v_mfma_f32_32x32x16_bf16 v[64:79], v[48:51], v[216:219], v[64:79]
  ds_read_b64_tr_b16 v[60:61], v8 offset:39936
  ds_read_b64_tr_b16 v[62:63], v8 offset:40192
  s_add_u32 m0, s97, 101376
  s_nop 0
  buffer_load_dwordx4 v14, s[4:7], s80 offen lds
  s_waitcnt lgkmcnt(4)
  v_mfma_f32_32x32x16_bf16 v[80:95], v[52:55], v[216:219], v[80:95]
  s_waitcnt vmcnt(4)
  s_barrier
  v_xor_b32 v4, 0x10000, v4
  v_xor_b32 v5, 0x10000, v5
  v_xor_b32 v6, 0x10000, v6
  v_xor_b32 v7, 0x10000, v7
  v_xor_b32 v8, 0x10000, v8
  ds_read_b128 v[224:227], v4 offset:0
  ds_read_b128 v[228:231], v5 offset:0
  ds_read_b128 v[232:235], v6 offset:0
  ds_read_b128 v[236:239], v7 offset:0
  ds_read_b64_tr_b16 v[48:49], v8 offset:0
  ds_read_b64_tr_b16 v[50:51], v8 offset:256
  s_waitcnt lgkmcnt(8)
  v_mfma_f32_32x32x16_bf16 v[64:79], v[56:59], v[220:223], v[64:79]
  ds_read_b64_tr_b16 v[52:53], v8 offset:4096
  ds_read_b64_tr_b16 v[54:55], v8 offset:4352
  s_add_u32 s76, s72, 1
  s_and_b32 s76, s76, 7
  s_mul_i32 s78, s76, 176128
  s_add_u32 s78, s78, s73
  s_add_u32 s78, s78, 64
  s_add_u32 s79, s78, s74
  s_add_u32 m0, s85, 16384
  s_nop 0
  buffer_load_dwordx4 v16, s[12:15], s78 offen lds
  s_waitcnt lgkmcnt(8)
  v_mfma_f32_32x32x16_bf16 v[80:95], v[60:63], v[220:223], v[80:95]
  ds_read_b64_tr_b16 v[56:57], v8 offset:1024
  ds_read_b64_tr_b16 v[58:59], v8 offset:1280
  s_waitcnt lgkmcnt(9)
  s_waitcnt lgkmcnt(4)
  v_mfma_f32_32x32x16_bf16 v[64:79], v[48:51], v[224:227], v[64:79]
  ds_read_b64_tr_b16 v[60:61], v8 offset:5120
  ds_read_b64_tr_b16 v[62:63], v8 offset:5376
  s_add_u32 m0, s85, 24576
  s_nop 0
  buffer_load_dwordx4 v16, s[12:15], s79 offen lds
  s_waitcnt lgkmcnt(4)
  v_mfma_f32_32x32x16_bf16 v[80:95], v[52:55], v[224:227], v[80:95]
  ds_read_b64_tr_b16 v[48:49], v8 offset:2048
  ds_read_b64_tr_b16 v[50:51], v8 offset:2304
  s_waitcnt lgkmcnt(4)
  v_mfma_f32_32x32x16_bf16 v[64:79], v[56:59], v[228:231], v[64:79]
  ds_read_b64_tr_b16 v[52:53], v8 offset:6144
  ds_read_b64_tr_b16 v[54:55], v8 offset:6400
  s_add_u32 m0, s85, 20480
  s_nop 0
  buffer_load_dwordx4 v16, s[68:71], s78 offen lds
  s_waitcnt lgkmcnt(4)
  v_mfma_f32_32x32x16_bf16 v[80:95], v[60:63], v[228:231], v[80:95]
  ds_read_b64_tr_b16 v[56:57], v8 offset:3072
  ds_read_b64_tr_b16 v[58:59], v8 offset:3328
  s_waitcnt lgkmcnt(4)
  v_mfma_f32_32x32x16_bf16 v[64:79], v[48:51], v[232:235], v[64:79]
  ds_read_b64_tr_b16 v[60:61], v8 offset:7168
  ds_read_b64_tr_b16 v[62:63], v8 offset:7424
  s_add_u32 m0, s85, 28672
  s_nop 0
  buffer_load_dwordx4 v16, s[68:71], s79 offen lds
  s_waitcnt lgkmcnt(4)
  v_mfma_f32_32x32x16_bf16 v[80:95], v[52:55], v[232:235], v[80:95]
  s_waitcnt vmcnt(4)
  s_barrier
  ds_read_b128 v[240:243], v4 offset:32768
  ds_read_b128 v[244:247], v5 offset:32768
  ds_read_b128 v[248:251], v6 offset:32768
  ds_read_b128 v[252:255], v7 offset:32768
  ds_read_b64_tr_b16 v[48:49], v8 offset:32768
  ds_read_b64_tr_b16 v[50:51], v8 offset:33024
  s_waitcnt lgkmcnt(8)
  v_mfma_f32_32x32x16_bf16 v[64:79], v[56:59], v[236:239], v[64:79]
  ds_read_b64_tr_b16 v[52:53], v8 offset:36864
  ds_read_b64_tr_b16 v[54:55], v8 offset:37120
  s_add_u32 s76, s72, 3
  s_and_b32 s76, s76, 7
  s_mul_i32 s78, s76, 176128
  s_add_u32 s78, s78, s73
  s_add_u32 s78, s78, 64
  s_add_u32 s79, s78, s74
  s_add_u32 m0, s85, 49152
  s_nop 0
  buffer_load_dwordx4 v16, s[12:15], s78 offen lds
  s_waitcnt lgkmcnt(8)
  v_mfma_f32_32x32x16_bf16 v[80:95], v[60:63], v[236:239], v[80:95]
  ds_read_b64_tr_b16 v[56:57], v8 offset:33792
  ds_read_b64_tr_b16 v[58:59], v8 offset:34048
  s_waitcnt lgkmcnt(9)
  s_waitcnt lgkmcnt(4)
  v_mfma_f32_32x32x16_bf16 v[64:79], v[48:51], v[240:243], v[64:79]
  ds_read_b64_tr_b16 v[60:61], v8 offset:37888
  ds_read_b64_tr_b16 v[62:63], v8 offset:38144
  s_add_u32 m0, s85, 57344
  s_nop 0
  buffer_load_dwordx4 v16, s[12:15], s79 offen lds
  s_waitcnt lgkmcnt(4)
  v_mfma_f32_32x32x16_bf16 v[80:95], v[52:55], v[240:243], v[80:95]
  ds_read_b64_tr_b16 v[48:49], v8 offset:34816
  ds_read_b64_tr_b16 v[50:51], v8 offset:35072
  s_waitcnt lgkmcnt(4)
  v_mfma_f32_32x32x16_bf16 v[64:79], v[56:59], v[244:247], v[64:79]
  ds_read_b64_tr_b16 v[52:53], v8 offset:38912
  ds_read_b64_tr_b16 v[54:55], v8 offset:39168
  s_add_u32 m0, s85, 53248
  s_nop 0
  buffer_load_dwordx4 v16, s[68:71], s78 offen lds
  s_waitcnt lgkmcnt(4)
  v_mfma_f32_32x32x16_bf16 v[80:95], v[60:63], v[244:247], v[80:95]
  ds_read_b64_tr_b16 v[56:57], v8 offset:35840
  ds_read_b64_tr_b16 v[58:59], v8 offset:36096
  s_waitcnt lgkmcnt(4)
  v_mfma_f32_32x32x16_bf16 v[64:79], v[48:51], v[248:251], v[64:79]
  ds_read_b64_tr_b16 v[60:61], v8 offset:39936
  ds_read_b64_tr_b16 v[62:63], v8 offset:40192
  s_add_u32 m0, s85, 61440
  s_nop 0
  buffer_load_dwordx4 v16, s[68:71], s79 offen lds
  s_waitcnt lgkmcnt(4)
  v_mfma_f32_32x32x16_bf16 v[80:95], v[52:55], v[248:251], v[80:95]
  s_waitcnt vmcnt(4)
  s_barrier
  ds_read_b64_tr_b16 v[48:49], v12 offset:0
  ds_read_b64_tr_b16 v[50:51], v12 offset:256
  s_waitcnt lgkmcnt(4)
  v_mfma_f32_32x32x16_bf16 v[64:79], v[56:59], v[252:255], v[64:79]
  ds_read_b64_tr_b16 v[52:53], v12 offset:4096
  ds_read_b64_tr_b16 v[54:55], v12 offset:4352
  s_add_u32 s76, s72, 5
  s_and_b32 s76, s76, 7
  s_mul_i32 s78, s76, 176128
  s_add_u32 s78, s78, s73
  s_add_u32 s78, s78, 64
  s_add_u32 s79, s78, s74
  s_add_u32 m0, s85, 81920
  s_nop 0
  buffer_load_dwordx4 v16, s[12:15], s78 offen lds
  s_waitcnt lgkmcnt(4)
  v_mfma_f32_32x32x16_bf16 v[80:95], v[60:63], v[252:255], v[80:95]
  ds_read_b64_tr_b16 v[56:57], v12 offset:1024
  ds_read_b64_tr_b16 v[58:59], v12 offset:1280
  s_waitcnt lgkmcnt(4)
  v_mfma_f32_32x32x16_bf16 v[96:111], v[48:51], v[128:131], v[96:111]
  ds_read_b64_tr_b16 v[60:61], v12 offset:5120
  ds_read_b64_tr_b16 v[62:63], v12 offset:5376
  s_lshl_b32 s81, s39, 11
  s_add_u32 s81, s81, s101
  v_and_b32 v17, 31, v1
  v_bfe_u32 v18, v17, 2, 1
  v_lshlrev_b32 v18, 4, v18
  v_lshrrev_b32 v19, 3, v17
  v_lshl_add_u32 v18, v19, 2, v18
  s_waitcnt lgkmcnt(4)
  v_mfma_f32_32x32x16_bf16 v[112:127], v[52:55], v[128:131], v[112:127]
  ds_read_b64_tr_b16 v[48:49], v12 offset:2048
  ds_read_b64_tr_b16 v[50:51], v12 offset:2304
  v_and_b32 v19, 3, v17
  v_add_u32 v18, v18, v19
  v_lshlrev_b32 v19, 5, v2
  v_add_u32 v18, v19, v18
  v_lshlrev_b32 v18, 3, v18
  v_add_u32 v18, 131072, v18
  ds_read_b64 v[40:41], v18 offset:17408
  s_waitcnt lgkmcnt(5)
  v_mfma_f32_32x32x16_bf16 v[96:111], v[56:59], v[132:135], v[96:111]
  ds_read_b64_tr_b16 v[52:53], v12 offset:6144
  ds_read_b64_tr_b16 v[54:55], v12 offset:6400
  s_add_u32 m0, s85, 90112
  s_nop 0
  buffer_load_dwordx4 v16, s[12:15], s79 offen lds
  s_waitcnt lgkmcnt(2)
  v_mov_b32 v46, 3184710632
  v_and_b32 v17, 31, v1
  v_lshlrev_b32 v17, 2, v17
  v_add_u32 v17, 147712, v17
  ds_read_b32 v18, v17 offset:0
  ds_read_b32 v19, v17 offset:128
  v_cmp_gt_u32 vcc, 32, v1
  v_lshlrev_b32 v3, 7, v1
  s_mul_i32 s76, s82, 44032
  s_lshl_b32 s77, s37, 11
  s_add_u32 s76, s76, s77
  s_add_u32 s76, s76, 0
  s_mov_b64 s[92:93], exec
  s_mov_b64 exec, 0xffff
  buffer_load_dword v15, v3, s[20:23], s76 offen
  s_mov_b64 exec, s[92:93]
  v_mfma_f32_32x32x16_bf16 v[112:127], v[60:63], v[132:135], v[112:127]
  ds_read_b64_tr_b16 v[56:57], v12 offset:3072
  ds_read_b64_tr_b16 v[58:59], v12 offset:3328
  v_mov_b32 v6, 0
  v_mov_b32 v7, 0
  v_cndmask_b32 v4, 0, v41, vcc
  v_mov_b32 v10, 0
  v_lshrrev_b32 v5, 16, v4
  v_mov_b32 v11, 0
  v_or_b32 v4, v4, v5
  v_mfma_f32_32x32x16_bf16 v[96:111], v[48:51], v[136:139], v[96:111]
  ds_read_b64_tr_b16 v[60:61], v12 offset:7168
  ds_read_b64_tr_b16 v[62:63], v12 offset:7424
  s_waitcnt lgkmcnt(4)
  v_cvt_pk_bf16_f32 v20, v18, v18
  v_lshlrev_b32 v20, 16, v20
  v_sub_f32 v20, v18, v20
  v_cvt_pk_bf16_f32 v8, v18, v20
  v_and_b32 v9, 0xffff0000, v8
  v_sub_f32 v20, v20, v9
  v_cvt_pk_bf16_f32 v9, v20, v10
  v_mfma_f32_32x32x16_bf16 v[112:127], v[52:55], v[136:139], v[112:127]
  ds_read_b64_tr_b16 v[48:49], v12 offset:16384
  ds_read_b64_tr_b16 v[50:51], v12 offset:16640
  s_add_u32 m0, s85, 86016
  s_nop 0
  buffer_load_dwordx4 v16, s[68:71], s78 offen lds
  s_nop 1
  v_mfma_f32_32x32x16_bf16 v[64:79], v[8:11], v[4:7], v[64:79]
  v_cvt_pk_bf16_f32 v20, v19, v19
  v_lshlrev_b32 v20, 16, v20
  v_sub_f32 v20, v19, v20
  v_cvt_pk_bf16_f32 v8, v19, v20
  v_and_b32 v9, 0xffff0000, v8
  s_waitcnt lgkmcnt(4)
  v_mfma_f32_32x32x16_bf16 v[96:111], v[56:59], v[140:143], v[96:111]
  ds_read_b64_tr_b16 v[52:53], v12 offset:20480
  ds_read_b64_tr_b16 v[54:55], v12 offset:20736
  v_sub_f32 v20, v20, v9
  v_cvt_pk_bf16_f32 v9, v20, v10
  s_nop 1
  v_mfma_f32_32x32x16_bf16 v[80:95], v[8:11], v[4:7], v[80:95]
  s_nop 15
  s_nop 3
  v_mul_f32 v64, v64, v40
  s_waitcnt lgkmcnt(4)
  v_mfma_f32_32x32x16_bf16 v[112:127], v[60:63], v[140:143], v[112:127]
  ds_read_b64_tr_b16 v[56:57], v12 offset:17408
  ds_read_b64_tr_b16 v[58:59], v12 offset:17664
  v_mul_f32 v65, v65, v40
  v_mul_f32 v66, v66, v40
  v_mul_f32 v67, v67, v40
  v_mul_f32 v17, v64, v64
  v_mul_f32 v18, v65, v65
  v_mul_f32 v19, v66, v66
  v_mul_f32 v20, v67, v67
  s_waitcnt lgkmcnt(4)
  v_mfma_f32_32x32x16_bf16 v[96:111], v[48:51], v[144:147], v[96:111]
  s_cmp_eq_u32 s86, 1
  s_cbranch_scc0 CSK_55
  v_mfma_f32_32x32x16_bf16 v[128:143], v[28:31], v[48:51], 0
CSK_55:
  ds_read_b64_tr_b16 v[60:61], v12 offset:21504
  ds_read_b64_tr_b16 v[62:63], v12 offset:21760
  s_add_u32 m0, s85, 94208
  s_nop 0
  buffer_load_dwordx4 v16, s[68:71], s79 offen lds
  v_fmaak_f32 v17, v46, v17, 3222493025
  v_fmaak_f32 v18, v46, v18, 3222493025
  v_fmaak_f32 v19, v46, v19, 3222493025
  v_fmaak_f32 v20, v46, v20, 3222493025
  v_mul_f32 v17, v17, v64
  v_mul_f32 v18, v18, v65
  v_mul_f32 v19, v19, v66
  s_waitcnt lgkmcnt(4)
  v_mfma_f32_32x32x16_bf16 v[112:127], v[52:55], v[144:147], v[112:127]
  s_cmp_eq_u32 s86, 2
  s_cbranch_scc0 CSK_56
  v_mfma_f32_32x32x16_bf16 v[128:143], v[28:31], v[52:55], 0
CSK_56:
  ds_read_b64_tr_b16 v[48:49], v12 offset:18432
  ds_read_b64_tr_b16 v[50:51], v12 offset:18688
  v_mul_f32 v20, v20, v67
  v_exp_f32 v17, v17
  v_exp_f32 v18, v18
  v_exp_f32 v19, v19
  v_exp_f32 v20, v20
  v_mul_f32 v21, v64, v80
  v_mul_f32 v22, v65, v81
  v_lshlrev_b32 v3, 7, v1
  s_mul_i32 s76, s82, 44032
  s_lshl_b32 s77, s37, 11
  s_add_u32 s76, s76, s77
  s_add_u32 s76, s76, 8192
  s_mov_b64 s[92:93], exec
  s_mov_b64 exec, 0xffff
  buffer_load_dword v15, v3, s[20:23], s76 offen
  s_mov_b64 exec, s[92:93]
  s_waitcnt lgkmcnt(4)
  v_mfma_f32_32x32x16_bf16 v[96:111], v[56:59], v[148:151], v[96:111]
  s_cmp_eq_u32 s86, 1
  s_cbranch_scc0 CSK_57
  v_mfma_f32_32x32x16_bf16 v[128:143], v[28:31], v[56:59], v[128:143]
CSK_57:
  ds_read_b64_tr_b16 v[52:53], v12 offset:22528
  ds_read_b64_tr_b16 v[54:55], v12 offset:22784
  v_mul_f32 v23, v66, v82
  v_mul_f32 v24, v67, v83
  v_add_f32 v17, 1.0, v17
  v_add_f32 v18, 1.0, v18
  v_add_f32 v19, 1.0, v19
  v_add_f32 v20, 1.0, v20
  v_rcp_f32 v17, v17
  s_waitcnt lgkmcnt(4)
  v_mfma_f32_32x32x16_bf16 v[112:127], v[60:63], v[148:151], v[112:127]
  s_cmp_eq_u32 s86, 2
  s_cbranch_scc0 CSK_58
  v_mfma_f32_32x32x16_bf16 v[128:143], v[28:31], v[60:63], v[128:143]
CSK_58:
  ds_read_b64_tr_b16 v[56:57], v12 offset:19456
  ds_read_b64_tr_b16 v[58:59], v12 offset:19712
  v_rcp_f32 v18, v18
  v_rcp_f32 v19, v19
  v_rcp_f32 v20, v20
  v_mul_f32 v21, v21, v40
  v_mul_f32 v22, v22, v40
  v_mul_f32 v23, v23, v40
  v_mul_f32 v24, v24, v40
  s_waitcnt lgkmcnt(4)
  v_mfma_f32_32x32x16_bf16 v[96:111], v[48:51], v[152:155], v[96:111]
  s_cmp_eq_u32 s86, 1
  s_cbranch_scc0 CSK_59
  v_mfma_f32_32x32x16_bf16 v[128:143], v[28:31], v[48:51], v[128:143]
CSK_59:
  ds_read_b64_tr_b16 v[60:61], v12 offset:23552
  ds_read_b64_tr_b16 v[62:63], v12 offset:23808
  v_mul_f32 v17, v17, v21
  v_mul_f32 v18, v18, v22
  v_mul_f32 v19, v19, v23
  v_mul_f32 v20, v20, v24
  v_cvt_pk_bf16_f32 v64, v17, v18
  v_cvt_pk_bf16_f32 v65, v19, v20
  v_mul_f32 v68, v68, v40
  s_waitcnt lgkmcnt(4)
  v_mfma_f32_32x32x16_bf16 v[112:127], v[52:55], v[152:155], v[112:127]
  s_cmp_eq_u32 s86, 2
  s_cbranch_scc0 CSK_60
  v_mfma_f32_32x32x16_bf16 v[128:143], v[28:31], v[52:55], v[128:143]
CSK_60:
  s_waitcnt vmcnt(6)
  s_barrier
  ds_read_b64_tr_b16 v[48:49], v12 offset:32768
  ds_read_b64_tr_b16 v[50:51], v12 offset:33024
  v_mul_f32 v69, v69, v40
  v_mul_f32 v70, v70, v40
  v_mul_f32 v71, v71, v40
  v_mul_f32 v17, v68, v68
  v_mul_f32 v18, v69, v69
  v_mul_f32 v19, v70, v70
  v_mul_f32 v20, v71, v71
  s_waitcnt lgkmcnt(4)
  v_mfma_f32_32x32x16_bf16 v[96:111], v[56:59], v[156:159], v[96:111]
  s_cmp_eq_u32 s86, 1
  s_cbranch_scc0 CSK_61
  v_mfma_f32_32x32x16_bf16 v[128:143], v[28:31], v[56:59], v[128:143]
CSK_61:
  ds_read_b64_tr_b16 v[52:53], v12 offset:36864
  ds_read_b64_tr_b16 v[54:55], v12 offset:37120
  s_add_u32 s76, s72, 7
  s_and_b32 s76, s76, 7
  s_mul_i32 s78, s76, 176128
  s_add_u32 s78, s78, s73
  s_add_u32 s78, s78, 64
  s_add_u32 s79, s78, s74
  s_add_u32 m0, s85, 114688
  s_nop 0
  buffer_load_dwordx4 v16, s[12:15], s78 offen lds
  v_fmaak_f32 v17, v46, v17, 3222493025
  v_fmaak_f32 v18, v46, v18, 3222493025
  v_fmaak_f32 v19, v46, v19, 3222493025
  v_fmaak_f32 v20, v46, v20, 3222493025
  v_mul_f32 v17, v17, v68
  v_mul_f32 v18, v18, v69
  v_mul_f32 v19, v19, v70
  s_waitcnt lgkmcnt(4)
  v_mfma_f32_32x32x16_bf16 v[112:127], v[60:63], v[156:159], v[112:127]
  s_cmp_eq_u32 s86, 2
  s_cbranch_scc0 CSK_62
  v_mfma_f32_32x32x16_bf16 v[128:143], v[28:31], v[60:63], v[128:143]
CSK_62:
  ds_read_b64_tr_b16 v[56:57], v12 offset:33792
  ds_read_b64_tr_b16 v[58:59], v12 offset:34048
  v_mul_f32 v20, v20, v71
  v_exp_f32 v17, v17
  v_exp_f32 v18, v18
  v_exp_f32 v19, v19
  v_exp_f32 v20, v20
  v_mul_f32 v21, v68, v84
  v_mul_f32 v22, v69, v85
  s_nop 7
  s_nop 7
  s_add_u32 s77, s72, 1
  s_and_b32 s77, s77, 7
  s_lshl_b32 s76, s39, 3
  s_add_u32 s76, s76, s77
  s_lshl_b32 s76, s76, 11
  s_sub_u32 s77, s86, 1
  s_lshl_b32 s77, s77, 8
  s_add_u32 s76, s76, s77
  s_add_u32 s76, s76, 11011584
  s_lshl_b32 s77, s2, 11
  s_add_u32 s77, s77, 11665408
  s_cmp_eq_u32 s86, 0
  s_cselect_b32 s76, s77, s76
  v_mov_b32 v129, s75
  v_lshlrev_b32 v130, 3, v1
  s_mov_b64 s[92:93], exec
  s_mov_b64 exec, 0xffffffff
  buffer_store_dwordx2 v[128:129], v130, s[16:19], s76 offen sc1
  s_mov_b64 exec, s[92:93]
  s_waitcnt lgkmcnt(4)
  v_mfma_f32_32x32x16_bf16 v[96:111], v[48:51], v[160:163], v[96:111]
  ds_read_b64_tr_b16 v[60:61], v12 offset:37888
  ds_read_b64_tr_b16 v[62:63], v12 offset:38144
  v_mul_f32 v23, v70, v86
  v_mul_f32 v24, v71, v87
  v_add_f32 v17, 1.0, v17
  v_add_f32 v18, 1.0, v18
  v_add_f32 v19, 1.0, v19
  v_add_f32 v20, 1.0, v20
  v_rcp_f32 v17, v17
  s_waitcnt lgkmcnt(4)
  v_mfma_f32_32x32x16_bf16 v[112:127], v[52:55], v[160:163], v[112:127]
  ds_read_b64_tr_b16 v[48:49], v12 offset:34816
  ds_read_b64_tr_b16 v[50:51], v12 offset:35072
  s_add_u32 m0, s85, 122880
  s_nop 0
  buffer_load_dwordx4 v16, s[12:15], s79 offen lds
  v_rcp_f32 v18, v18
  v_rcp_f32 v19, v19
  v_rcp_f32 v20, v20
  v_mul_f32 v21, v21, v40
  v_mul_f32 v22, v22, v40
  v_mul_f32 v23, v23, v40
  v_mul_f32 v24, v24, v40
  s_waitcnt lgkmcnt(4)
  v_mfma_f32_32x32x16_bf16 v[96:111], v[56:59], v[164:167], v[96:111]
  ds_read_b64_tr_b16 v[52:53], v12 offset:38912
  ds_read_b64_tr_b16 v[54:55], v12 offset:39168
  v_mul_f32 v17, v17, v21
  v_mul_f32 v18, v18, v22
  v_mul_f32 v19, v19, v23
  v_mul_f32 v20, v20, v24
  v_cvt_pk_bf16_f32 v66, v17, v18
  v_cvt_pk_bf16_f32 v67, v19, v20
  v_mul_f32 v72, v72, v40
  v_lshlrev_b32 v3, 7, v1
  s_mul_i32 s76, s82, 44032
  s_lshl_b32 s77, s37, 11
  s_add_u32 s76, s76, s77
  s_add_u32 s76, s76, 16384
  s_mov_b64 s[92:93], exec
  s_mov_b64 exec, 0xffff
  buffer_load_dword v15, v3, s[20:23], s76 offen
  s_mov_b64 exec, s[92:93]
  s_waitcnt lgkmcnt(4)
  v_mfma_f32_32x32x16_bf16 v[112:127], v[60:63], v[164:167], v[112:127]
  ds_read_b64_tr_b16 v[56:57], v12 offset:35840
  ds_read_b64_tr_b16 v[58:59], v12 offset:36096
  v_mul_f32 v73, v73, v40
  v_mul_f32 v74, v74, v40
  v_mul_f32 v75, v75, v40
  v_mul_f32 v17, v72, v72
  v_mul_f32 v18, v73, v73
  v_mul_f32 v19, v74, v74
  v_mul_f32 v20, v75, v75
  s_waitcnt lgkmcnt(4)
  v_mfma_f32_32x32x16_bf16 v[96:111], v[48:51], v[168:171], v[96:111]
  ds_read_b64_tr_b16 v[60:61], v12 offset:39936
  ds_read_b64_tr_b16 v[62:63], v12 offset:40192
  s_add_u32 m0, s85, 118784
  s_nop 0
  buffer_load_dwordx4 v16, s[68:71], s78 offen lds
  v_fmaak_f32 v17, v46, v17, 3222493025
  v_fmaak_f32 v18, v46, v18, 3222493025
  v_fmaak_f32 v19, v46, v19, 3222493025
  v_fmaak_f32 v20, v46, v20, 3222493025
  v_mul_f32 v17, v17, v72
  v_mul_f32 v18, v18, v73
  v_mul_f32 v19, v19, v74
  s_waitcnt lgkmcnt(4)
  v_mfma_f32_32x32x16_bf16 v[112:127], v[52:55], v[168:171], v[112:127]
  ds_read_b64_tr_b16 v[48:49], v12 offset:49152
  ds_read_b64_tr_b16 v[50:51], v12 offset:49408
  v_mul_f32 v20, v20, v75
  v_exp_f32 v17, v17
  v_exp_f32 v18, v18
  v_exp_f32 v19, v19
  v_exp_f32 v20, v20
  v_mul_f32 v21, v72, v88
  v_mul_f32 v22, v73, v89
  s_waitcnt lgkmcnt(4)
  v_mfma_f32_32x32x16_bf16 v[96:111], v[56:59], v[172:175], v[96:111]
  ds_read_b64_tr_b16 v[52:53], v12 offset:53248
  ds_read_b64_tr_b16 v[54:55], v12 offset:53504
  v_mul_f32 v23, v74, v90
  v_mul_f32 v24, v75, v91
  v_add_f32 v17, 1.0, v17
  v_add_f32 v18, 1.0, v18
  v_add_f32 v19, 1.0, v19
  v_add_f32 v20, 1.0, v20
  v_rcp_f32 v17, v17
  s_waitcnt lgkmcnt(4)
  v_mfma_f32_32x32x16_bf16 v[112:127], v[60:63], v[172:175], v[112:127]
  ds_read_b64_tr_b16 v[56:57], v12 offset:50176
  ds_read_b64_tr_b16 v[58:59], v12 offset:50432
  s_add_u32 m0, s85, 126976
  s_nop 0
  buffer_load_dwordx4 v16, s[68:71], s79 offen lds
  v_rcp_f32 v18, v18
  v_rcp_f32 v19, v19
  v_rcp_f32 v20, v20
  v_mul_f32 v21, v21, v40
  v_mul_f32 v22, v22, v40
  v_mul_f32 v23, v23, v40
  v_mul_f32 v24, v24, v40
  s_waitcnt lgkmcnt(4)
  v_mfma_f32_32x32x16_bf16 v[96:111], v[48:51], v[176:179], v[96:111]
  ds_read_b64_tr_b16 v[60:61], v12 offset:54272
  ds_read_b64_tr_b16 v[62:63], v12 offset:54528
  v_mul_f32 v17, v17, v21
  v_mul_f32 v18, v18, v22
  v_mul_f32 v19, v19, v23
  v_mul_f32 v20, v20, v24
  v_cvt_pk_bf16_f32 v68, v17, v18
  v_cvt_pk_bf16_f32 v69, v19, v20
  v_mul_f32 v76, v76, v40
  s_waitcnt lgkmcnt(4)
  v_mfma_f32_32x32x16_bf16 v[112:127], v[52:55], v[176:179], v[112:127]
  ds_read_b64_tr_b16 v[48:49], v12 offset:51200
  ds_read_b64_tr_b16 v[50:51], v12 offset:51456
  v_mul_f32 v77, v77, v40
  v_mul_f32 v78, v78, v40
  v_mul_f32 v79, v79, v40
  v_mul_f32 v17, v76, v76
  v_mul_f32 v18, v77, v77
  v_mul_f32 v19, v78, v78
  v_mul_f32 v20, v79, v79
  v_lshlrev_b32 v3, 7, v1
  s_mul_i32 s76, s82, 44032
  s_lshl_b32 s77, s37, 11
  s_add_u32 s76, s76, s77
  s_add_u32 s76, s76, 24576
  s_mov_b64 s[92:93], exec
  s_mov_b64 exec, 0xffff
  buffer_load_dword v15, v3, s[20:23], s76 offen
  s_mov_b64 exec, s[92:93]
  s_waitcnt lgkmcnt(4)
  v_mfma_f32_32x32x16_bf16 v[96:111], v[56:59], v[180:183], v[96:111]
  ds_read_b64_tr_b16 v[52:53], v12 offset:55296
  ds_read_b64_tr_b16 v[54:55], v12 offset:55552
  v_fmaak_f32 v17, v46, v17, 3222493025
  v_fmaak_f32 v18, v46, v18, 3222493025
  v_fmaak_f32 v19, v46, v19, 3222493025
  v_fmaak_f32 v20, v46, v20, 3222493025
  v_mul_f32 v17, v17, v76
  v_mul_f32 v18, v18, v77
  v_mul_f32 v19, v19, v78
  s_waitcnt lgkmcnt(4)
  v_mfma_f32_32x32x16_bf16 v[112:127], v[60:63], v[180:183], v[112:127]
  ds_read_b64_tr_b16 v[56:57], v12 offset:52224
  ds_read_b64_tr_b16 v[58:59], v12 offset:52480
  v_mul_f32 v20, v20, v79
  v_exp_f32 v17, v17
  v_exp_f32 v18, v18
  v_exp_f32 v19, v19
  v_exp_f32 v20, v20
  v_mul_f32 v21, v76, v92
  v_mul_f32 v22, v77, v93
  s_waitcnt lgkmcnt(4)
  v_mfma_f32_32x32x16_bf16 v[96:111], v[48:51], v[184:187], v[96:111]
  ds_read_b64_tr_b16 v[60:61], v12 offset:56320
  ds_read_b64_tr_b16 v[62:63], v12 offset:56576
  v_mul_f32 v23, v78, v94
  v_mul_f32 v24, v79, v95
  v_add_f32 v17, 1.0, v17
  v_add_f32 v18, 1.0, v18
  v_add_f32 v19, 1.0, v19
  v_add_f32 v20, 1.0, v20
  v_rcp_f32 v17, v17
  s_waitcnt lgkmcnt(4)
  v_mfma_f32_32x32x16_bf16 v[112:127], v[52:55], v[184:187], v[112:127]
  s_waitcnt vmcnt(8)
  s_barrier
  v_xor_b32 v12, 0x10000, v12
  ds_read_b64_tr_b16 v[48:49], v12 offset:0
  ds_read_b64_tr_b16 v[50:51], v12 offset:256
  s_add_u32 s77, s98, 0
  s_add_u32 m0, s89, 0
  s_nop 0
  buffer_load_dwordx4 v43, s[20:23], s77 offen lds
  v_rcp_f32 v18, v18
  v_rcp_f32 v19, v19
  v_rcp_f32 v20, v20
  v_mul_f32 v21, v21, v40
  v_mul_f32 v22, v22, v40
  v_mul_f32 v23, v23, v40
  v_mul_f32 v24, v24, v40
  s_waitcnt lgkmcnt(4)
  v_mfma_f32_32x32x16_bf16 v[96:111], v[56:59], v[188:191], v[96:111]
  ds_read_b64_tr_b16 v[52:53], v12 offset:4096
  ds_read_b64_tr_b16 v[54:55], v12 offset:4352
  v_mul_f32 v17, v17, v21
  v_mul_f32 v18, v18, v22
  v_mul_f32 v19, v19, v23
  v_mul_f32 v20, v20, v24
  v_cvt_pk_bf16_f32 v70, v17, v18
  v_cvt_pk_bf16_f32 v71, v19, v20
  v_lshlrev_b32 v17, 4, v1
  s_waitcnt lgkmcnt(4)
  v_mfma_f32_32x32x16_bf16 v[112:127], v[60:63], v[188:191], v[112:127]
  ds_read_b64_tr_b16 v[56:57], v12 offset:1024
  ds_read_b64_tr_b16 v[58:59], v12 offset:1280
  buffer_store_dwordx4 v[64:67], v17, s[16:19], s81 offen sc1
  buffer_store_dwordx4 v[68:71], v17, s[16:19], s81 offen offset:1024 sc1
  s_waitcnt lgkmcnt(4)
  v_mfma_f32_32x32x16_bf16 v[96:111], v[48:51], v[192:195], v[96:111]
  ds_read_b64_tr_b16 v[60:61], v12 offset:5120
  ds_read_b64_tr_b16 v[62:63], v12 offset:5376
  s_add_u32 s77, s98, 8192
  s_add_u32 m0, s89, 1024
  s_nop 0
  buffer_load_dwordx4 v43, s[20:23], s77 offen lds
  s_waitcnt lgkmcnt(4)
  v_mfma_f32_32x32x16_bf16 v[112:127], v[52:55], v[192:195], v[112:127]
  ds_read_b64_tr_b16 v[48:49], v12 offset:2048
  ds_read_b64_tr_b16 v[50:51], v12 offset:2304
  s_waitcnt lgkmcnt(4)
  v_mfma_f32_32x32x16_bf16 v[96:111], v[56:59], v[196:199], v[96:111]
  ds_read_b64_tr_b16 v[52:53], v12 offset:6144
  ds_read_b64_tr_b16 v[54:55], v12 offset:6400
  v_lshlrev_b32 v3, 7, v1
  s_mul_i32 s76, s82, 44032
  s_lshl_b32 s77, s37, 11
  s_add_u32 s76, s76, s77
  s_add_u32 s76, s76, 32768
  s_mov_b64 s[92:93], exec
  s_mov_b64 exec, 0xffff
  buffer_load_dword v15, v3, s[20:23], s76 offen
  s_mov_b64 exec, s[92:93]
  s_waitcnt lgkmcnt(4)
  v_mfma_f32_32x32x16_bf16 v[112:127], v[60:63], v[196:199], v[112:127]
  ds_read_b64_tr_b16 v[56:57], v12 offset:3072
  ds_read_b64_tr_b16 v[58:59], v12 offset:3328
  s_add_u32 s77, s98, 393216
  s_add_u32 m0, s89, 16384
  s_nop 0
  buffer_load_dwordx4 v43, s[20:23], s77 offen lds
  s_waitcnt lgkmcnt(4)
  v_mfma_f32_32x32x16_bf16 v[96:111], v[48:51], v[200:203], v[96:111]
  ds_read_b64_tr_b16 v[60:61], v12 offset:7168
  ds_read_b64_tr_b16 v[62:63], v12 offset:7424
  s_waitcnt lgkmcnt(4)
  v_mfma_f32_32x32x16_bf16 v[112:127], v[52:55], v[200:203], v[112:127]
  ds_read_b64_tr_b16 v[48:49], v12 offset:16384
  ds_read_b64_tr_b16 v[50:51], v12 offset:16640
  s_waitcnt lgkmcnt(4)
  v_mfma_f32_32x32x16_bf16 v[96:111], v[56:59], v[204:207], v[96:111]
  ds_read_b64_tr_b16 v[52:53], v12 offset:20480
  ds_read_b64_tr_b16 v[54:55], v12 offset:20736
  s_add_u32 s77, s98, 401408
  s_add_u32 m0, s89, 17408
  s_nop 0
  buffer_load_dwordx4 v43, s[20:23], s77 offen lds
  s_waitcnt lgkmcnt(4)
  v_mfma_f32_32x32x16_bf16 v[112:127], v[60:63], v[204:207], v[112:127]
  ds_read_b64_tr_b16 v[56:57], v12 offset:17408
  ds_read_b64_tr_b16 v[58:59], v12 offset:17664
  s_waitcnt lgkmcnt(4)
  v_mfma_f32_32x32x16_bf16 v[96:111], v[48:51], v[208:211], v[96:111]
  ds_read_b64_tr_b16 v[60:61], v12 offset:21504
  ds_read_b64_tr_b16 v[62:63], v12 offset:21760
  s_waitcnt lgkmcnt(4)
  v_mfma_f32_32x32x16_bf16 v[112:127], v[52:55], v[208:211], v[112:127]
  ds_read_b64_tr_b16 v[48:49], v12 offset:18432
  ds_read_b64_tr_b16 v[50:51], v12 offset:18688
  v_lshlrev_b32 v3, 7, v1
  s_mul_i32 s76, s82, 44032
  s_lshl_b32 s77, s37, 11
  s_add_u32 s76, s76, s77
  s_add_u32 s76, s76, 40960
  s_mov_b64 s[92:93], exec
  s_mov_b64 exec, 0xffff
  buffer_load_dword v15, v3, s[20:23], s76 offen
  s_mov_b64 exec, s[92:93]
  s_waitcnt lgkmcnt(4)
  v_mfma_f32_32x32x16_bf16 v[96:111], v[56:59], v[212:215], v[96:111]
  ds_read_b64_tr_b16 v[52:53], v12 offset:22528
  ds_read_b64_tr_b16 v[54:55], v12 offset:22784
  s_waitcnt lgkmcnt(4)
  v_mfma_f32_32x32x16_bf16 v[112:127], v[60:63], v[212:215], v[112:127]
  ds_read_b64_tr_b16 v[56:57], v12 offset:19456
  ds_read_b64_tr_b16 v[58:59], v12 offset:19712
  s_waitcnt lgkmcnt(4)
  v_mfma_f32_32x32x16_bf16 v[96:111], v[48:51], v[216:219], v[96:111]
  ds_read_b64_tr_b16 v[60:61], v12 offset:23552
  ds_read_b64_tr_b16 v[62:63], v12 offset:23808
  s_waitcnt lgkmcnt(4)
  v_mfma_f32_32x32x16_bf16 v[112:127], v[52:55], v[216:219], v[112:127]
  s_waitcnt vmcnt(5)
  s_lshl_b32 s76, s38, 11
  s_lshl_b32 s77, s39, 4
  s_add_u32 s76, s76, s77
  s_lshl_b32 s77, s37, 2
  s_add_u32 s76, s76, s77
  s_add_u32 s76, s76, 11534336
  v_mov_b32 v26, 0
  v_mov_b32 v27, s75
  s_mov_b64 s[92:93], exec
  s_mov_b64 exec, 1
  buffer_store_dword v27, v26, s[16:19], s76 offen sc1
  s_mov_b64 exec, s[92:93]
  s_barrier
  ds_read_b64_tr_b16 v[48:49], v12 offset:32768
  ds_read_b64_tr_b16 v[50:51], v12 offset:33024
  s_waitcnt lgkmcnt(4)
  v_mfma_f32_32x32x16_bf16 v[96:111], v[56:59], v[220:223], v[96:111]
  ds_read_b64_tr_b16 v[52:53], v12 offset:36864
  ds_read_b64_tr_b16 v[54:55], v12 offset:37120
  s_waitcnt lgkmcnt(4)
  v_mfma_f32_32x32x16_bf16 v[112:127], v[60:63], v[220:223], v[112:127]
  ds_read_b64_tr_b16 v[56:57], v12 offset:33792
  ds_read_b64_tr_b16 v[58:59], v12 offset:34048
  s_add_u32 s77, s98, 786432
  s_add_u32 m0, s89, 32768
  s_nop 0
  buffer_load_dwordx4 v43, s[20:23], s77 offen lds
  s_cmp_lt_u32 s37, 2
  s_cbranch_scc0 G_63
  s_lshl_b32 s76, s39, 14
  s_add_u32 s76, s76, 11011072
  s_lshl_b32 s77, s37, 9
  s_add_u32 s76, s76, s77
  v_lshlrev_b32 v3, 3, v1
  s_add_u32 s77, s76, 0
  buffer_load_dwordx2 v[144:145], v3, s[16:19], s77 offen offset:0 sc1
  s_add_u32 s77, s76, 0
  buffer_load_dwordx2 v[146:147], v3, s[16:19], s77 offen offset:2048 sc1
  s_add_u32 s77, s76, 4096
  buffer_load_dwordx2 v[148:149], v3, s[16:19], s77 offen offset:0 sc1
  s_add_u32 s77, s76, 4096
  buffer_load_dwordx2 v[150:151], v3, s[16:19], s77 offen offset:2048 sc1
  s_add_u32 s77, s76, 8192
  buffer_load_dwordx2 v[152:153], v3, s[16:19], s77 offen offset:0 sc1
  s_add_u32 s77, s76, 8192
  buffer_load_dwordx2 v[154:155], v3, s[16:19], s77 offen offset:2048 sc1
  s_add_u32 s77, s76, 12288
  buffer_load_dwordx2 v[156:157], v3, s[16:19], s77 offen offset:0 sc1
  s_add_u32 s77, s76, 12288
  buffer_load_dwordx2 v[158:159], v3, s[16:19], s77 offen offset:2048 sc1
  s_branch G_64
G_63:
  s_mov_b32 s76, 0x40000000
  buffer_load_dword v152, v1, s[16:19], s76 offen
  buffer_load_dword v153, v1, s[16:19], s76 offen
  buffer_load_dword v154, v1, s[16:19], s76 offen
  buffer_load_dword v155, v1, s[16:19], s76 offen
  buffer_load_dword v156, v1, s[16:19], s76 offen
  buffer_load_dword v157, v1, s[16:19], s76 offen
  buffer_load_dword v158, v1, s[16:19], s76 offen
  buffer_load_dword v159, v1, s[16:19], s76 offen
G_64:
  s_waitcnt lgkmcnt(4)
  v_mfma_f32_32x32x16_bf16 v[96:111], v[48:51], v[224:227], v[96:111]
  ds_read_b64_tr_b16 v[60:61], v12 offset:37888
  ds_read_b64_tr_b16 v[62:63], v12 offset:38144
  s_waitcnt lgkmcnt(4)
  v_mfma_f32_32x32x16_bf16 v[112:127], v[52:55], v[224:227], v[112:127]
  ds_read_b64_tr_b16 v[48:49], v12 offset:34816
  ds_read_b64_tr_b16 v[50:51], v12 offset:35072
  s_waitcnt lgkmcnt(4)
  v_mfma_f32_32x32x16_bf16 v[96:111], v[56:59], v[228:231], v[96:111]
  ds_read_b64_tr_b16 v[52:53], v12 offset:38912
  ds_read_b64_tr_b16 v[54:55], v12 offset:39168
  s_add_u32 s77, s98, 794624
  s_add_u32 m0, s89, 33792
  s_nop 0
  buffer_load_dwordx4 v43, s[20:23], s77 offen lds
  v_lshlrev_b32 v3, 7, v1
  s_lshl_b32 s76, s82, 14
  s_lshl_b32 s77, s37, 11
  s_add_u32 s76, s76, s77
  s_add_u32 s76, s76, 0
  s_mov_b64 s[92:93], exec
  s_mov_b64 exec, 0xffff
  buffer_load_dword v15, v3, s[24:27], s76 offen
  s_mov_b64 exec, s[92:93]
  s_waitcnt lgkmcnt(4)
  v_mfma_f32_32x32x16_bf16 v[112:127], v[60:63], v[228:231], v[112:127]
  ds_read_b64_tr_b16 v[56:57], v12 offset:35840
  ds_read_b64_tr_b16 v[58:59], v12 offset:36096
  s_waitcnt lgkmcnt(4)
  v_mfma_f32_32x32x16_bf16 v[96:111], v[48:51], v[232:235], v[96:111]
  ds_read_b64_tr_b16 v[60:61], v12 offset:39936
  ds_read_b64_tr_b16 v[62:63], v12 offset:40192
  s_waitcnt lgkmcnt(4)
  v_mfma_f32_32x32x16_bf16 v[112:127], v[52:55], v[232:235], v[112:127]
  ds_read_b64_tr_b16 v[48:49], v12 offset:49152
  ds_read_b64_tr_b16 v[50:51], v12 offset:49408
  s_add_u32 s77, s99, 1146880
  s_add_u32 m0, s89, 49152
  s_nop 0
  buffer_load_dwordx4 v43, s[20:23], s77 offen lds
  s_waitcnt lgkmcnt(4)
  v_mfma_f32_32x32x16_bf16 v[96:111], v[56:59], v[236:239], v[96:111]
  ds_read_b64_tr_b16 v[52:53], v12 offset:53248
  ds_read_b64_tr_b16 v[54:55], v12 offset:53504
  s_waitcnt lgkmcnt(4)
  v_mfma_f32_32x32x16_bf16 v[112:127], v[60:63], v[236:239], v[112:127]
  ds_read_b64_tr_b16 v[56:57], v12 offset:50176
  ds_read_b64_tr_b16 v[58:59], v12 offset:50432
  s_waitcnt lgkmcnt(4)
  v_mfma_f32_32x32x16_bf16 v[96:111], v[48:51], v[240:243], v[96:111]
  ds_read_b64_tr_b16 v[60:61], v12 offset:54272
  ds_read_b64_tr_b16 v[62:63], v12 offset:54528
  s_add_u32 s77, s99, 1155072
  s_add_u32 m0, s89, 50176
  s_nop 0
  buffer_load_dwordx4 v43, s[20:23], s77 offen lds
  s_waitcnt lgkmcnt(4)
  v_mfma_f32_32x32x16_bf16 v[112:127], v[52:55], v[240:243], v[112:127]
  ds_read_b64_tr_b16 v[48:49], v12 offset:51200
  ds_read_b64_tr_b16 v[50:51], v12 offset:51456
  v_lshlrev_b32 v3, 7, v1
  s_lshl_b32 s76, s82, 14
  s_lshl_b32 s77, s37, 11
  s_add_u32 s76, s76, s77
  s_add_u32 s76, s76, 8192
  s_mov_b64 s[92:93], exec
  s_mov_b64 exec, 0xffff
  buffer_load_dword v15, v3, s[24:27], s76 offen
  s_mov_b64 exec, s[92:93]
  s_waitcnt lgkmcnt(4)
  v_mfma_f32_32x32x16_bf16 v[96:111], v[56:59], v[244:247], v[96:111]
  ds_read_b64_tr_b16 v[52:53], v12 offset:55296
  ds_read_b64_tr_b16 v[54:55], v12 offset:55552
  s_waitcnt lgkmcnt(4)
  v_mfma_f32_32x32x16_bf16 v[112:127], v[60:63], v[244:247], v[112:127]
  ds_read_b64_tr_b16 v[56:57], v12 offset:52224
  ds_read_b64_tr_b16 v[58:59], v12 offset:52480
  s_waitcnt lgkmcnt(4)
  v_mfma_f32_32x32x16_bf16 v[96:111], v[48:51], v[248:251], v[96:111]
  ds_read_b64_tr_b16 v[60:61], v12 offset:56320
  ds_read_b64_tr_b16 v[62:63], v12 offset:56576
  s_waitcnt lgkmcnt(4)
  v_mfma_f32_32x32x16_bf16 v[112:127], v[52:55], v[248:251], v[112:127]
  s_waitcnt lgkmcnt(2)
  v_mfma_f32_32x32x16_bf16 v[96:111], v[56:59], v[252:255], v[96:111]
  s_waitcnt lgkmcnt(0)
  v_mfma_f32_32x32x16_bf16 v[112:127], v[60:63], v[252:255], v[112:127]
  s_mov_b32 s91, 0
  s_waitcnt vmcnt(5)
  s_branch GF_70
GF_65:
  s_waitcnt vmcnt(0)
GF_70:
  s_cmp_lt_u32 s37, 2
  s_cbranch_scc0 GF_66
  s_mov_b64 s[94:95], 0
  v_cmp_ne_u32 vcc, s75, v145
  s_or_b64 s[94:95], s[94:95], vcc
  v_cmp_ne_u32 vcc, s75, v147
  s_or_b64 s[94:95], s[94:95], vcc
  v_cmp_ne_u32 vcc, s75, v149
  s_or_b64 s[94:95], s[94:95], vcc
  v_cmp_ne_u32 vcc, s75, v151
  s_or_b64 s[94:95], s[94:95], vcc
  v_cmp_ne_u32 vcc, s75, v153
  s_or_b64 s[94:95], s[94:95], vcc
  v_cmp_ne_u32 vcc, s75, v155
  s_or_b64 s[94:95], s[94:95], vcc
  v_cmp_ne_u32 vcc, s75, v157
  s_or_b64 s[94:95], s[94:95], vcc
  v_cmp_ne_u32 vcc, s75, v159
  s_or_b64 s[94:95], s[94:95], vcc
  s_cmp_eq_u64 s[94:95], 0
  s_cbranch_scc1 GF_68
  s_add_u32 s91, s91, 1
  s_cmp_gt_u32 s91, 200000
  s_cbranch_scc1 GF_68
  s_cmp_lt_u32 s37, 2
  s_cbranch_scc0 G_71
  s_lshl_b32 s76, s39, 14
  s_add_u32 s76, s76, 11011072
  s_lshl_b32 s77, s37, 9
  s_add_u32 s76, s76, s77
  v_lshlrev_b32 v3, 3, v1
  s_add_u32 s77, s76, 0
  buffer_load_dwordx2 v[144:145], v3, s[16:19], s77 offen offset:0 sc1
  s_add_u32 s77, s76, 0
  buffer_load_dwordx2 v[146:147], v3, s[16:19], s77 offen offset:2048 sc1
  s_add_u32 s77, s76, 4096
  buffer_load_dwordx2 v[148:149], v3, s[16:19], s77 offen offset:0 sc1
  s_add_u32 s77, s76, 4096
  buffer_load_dwordx2 v[150:151], v3, s[16:19], s77 offen offset:2048 sc1
  s_add_u32 s77, s76, 8192
  buffer_load_dwordx2 v[152:153], v3, s[16:19], s77 offen offset:0 sc1
  s_add_u32 s77, s76, 8192
  buffer_load_dwordx2 v[154:155], v3, s[16:19], s77 offen offset:2048 sc1
  s_add_u32 s77, s76, 12288
  buffer_load_dwordx2 v[156:157], v3, s[16:19], s77 offen offset:0 sc1
  s_add_u32 s77, s76, 12288
  buffer_load_dwordx2 v[158:159], v3, s[16:19], s77 offen offset:2048 sc1
  s_branch G_72
G_71:
  s_mov_b32 s76, 0x40000000
  buffer_load_dword v152, v1, s[16:19], s76 offen
  buffer_load_dword v153, v1, s[16:19], s76 offen
  buffer_load_dword v154, v1, s[16:19], s76 offen
  buffer_load_dword v155, v1, s[16:19], s76 offen
  buffer_load_dword v156, v1, s[16:19], s76 offen
  buffer_load_dword v157, v1, s[16:19], s76 offen
  buffer_load_dword v158, v1, s[16:19], s76 offen
  buffer_load_dword v159, v1, s[16:19], s76 offen
G_72:
  s_branch GF_65
GF_68:
  v_add_f32 v144, v144, v146
  v_add_f32 v148, v148, v150
  v_add_f32 v152, v152, v154
  v_add_f32 v156, v156, v158
  v_add_f32 v144, v144, v148
  v_add_f32 v152, v152, v156
  v_add_f32 v144, v144, v152
  s_lshl_b32 s76, s37, 8
  s_add_u32 s76, s76, 131072
  v_lshlrev_b32 v3, 2, v1
  v_add_u32 v3, s76, v3
  ds_write_b32 v3, v144 offset:16896
  s_branch GF_67
GF_66:
GF_67:
  s_waitcnt lgkmcnt(0)
  s_lshr_b32 s76, s87, 1
  s_lshl_b32 s76, s76, 11
  s_add_u32 s76, s76, 11534336
  v_lshlrev_b32 v17, 2, v1
  s_mov_b32 s91, 0
  buffer_load_dword v248, v17, s[16:19], s76 offen sc1
  s_sleep 2
  buffer_load_dword v250, v17, s[16:19], s76 offen sc1
  s_sleep 2
  buffer_load_dword v252, v17, s[16:19], s76 offen sc1
  s_sleep 2
PF_73:
  s_waitcnt vmcnt(2)
  v_cmp_ne_u32 vcc, s75, v248
  s_add_u32 s91, s91, 1
  s_cbranch_vccz PFOK_74
  buffer_load_dword v248, v17, s[16:19], s76 offen sc1
  s_waitcnt vmcnt(2)
  v_cmp_ne_u32 vcc, s75, v250
  s_add_u32 s91, s91, 1
  s_cbranch_vccz PFOK_74
  buffer_load_dword v250, v17, s[16:19], s76 offen sc1
  s_waitcnt vmcnt(2)
  v_cmp_ne_u32 vcc, s75, v252
  s_add_u32 s91, s91, 1
  s_cbranch_vccz PFOK_74
  buffer_load_dword v252, v17, s[16:19], s76 offen sc1
  s_cmp_gt_u32 s91, 200000
  s_cbranch_scc0 PF_73
PFOK_74:
  s_mov_b32 s77, 0
  buffer_load_dwordx4 v[128:131], v42, s[16:19], s77 offen sc1
  buffer_load_dwordx4 v[132:135], v42, s[16:19], s77 offen offset:1024 sc1
  s_mov_b32 s77, 8192
  buffer_load_dwordx4 v[136:139], v42, s[16:19], s77 offen sc1
  buffer_load_dwordx4 v[140:143], v42, s[16:19], s77 offen offset:1024 sc1
  s_mov_b32 s77, 16384
  buffer_load_dwordx4 v[144:147], v42, s[16:19], s77 offen sc1
  buffer_load_dwordx4 v[148:151], v42, s[16:19], s77 offen offset:1024 sc1
  s_mov_b32 s77, 24576
  buffer_load_dwordx4 v[152:155], v42, s[16:19], s77 offen sc1
  buffer_load_dwordx4 v[156:159], v42, s[16:19], s77 offen offset:1024 sc1
  s_barrier
  s_cmp_ge_u32 s39, 11
  s_cbranch_scc1 U2S_79
  s_lshl_b32 s81, s39, 11
  s_add_u32 s81, s81, s101
  s_add_u32 s81, s81, 65536
  v_mov_b32 v46, 3184710632
  v_and_b32 v17, 31, v1
  v_lshlrev_b32 v17, 2, v17
  v_add_u32 v17, 148224, v17
  ds_read_b32 v18, v17 offset:0
  ds_read_b32 v19, v17 offset:128
  v_cmp_gt_u32 vcc, 32, v1
  v_mov_b32 v50, 0
  v_mov_b32 v51, 0
  v_cndmask_b32 v48, 0, v41, vcc
  v_mov_b32 v54, 0
  v_lshrrev_b32 v49, 16, v48
  v_mov_b32 v55, 0
  v_or_b32 v48, v48, v49
  s_waitcnt lgkmcnt(0)
  v_cvt_pk_bf16_f32 v20, v18, v18
  v_lshlrev_b32 v20, 16, v20
  v_sub_f32 v20, v18, v20
  v_cvt_pk_bf16_f32 v52, v18, v20
  v_and_b32 v53, 0xffff0000, v52
  v_sub_f32 v20, v20, v53
  v_cvt_pk_bf16_f32 v53, v20, v54
  s_nop 1
  v_mfma_f32_32x32x16_bf16 v[96:111], v[52:55], v[48:51], v[96:111]
  v_cvt_pk_bf16_f32 v20, v19, v19
  v_lshlrev_b32 v20, 16, v20
  v_sub_f32 v20, v19, v20
  v_cvt_pk_bf16_f32 v52, v19, v20
  v_and_b32 v53, 0xffff0000, v52
  v_sub_f32 v20, v20, v53
  v_cvt_pk_bf16_f32 v53, v20, v54
  s_nop 1
  v_mfma_f32_32x32x16_bf16 v[112:127], v[52:55], v[48:51], v[112:127]
  s_nop 15
  s_nop 3
  v_mul_f32 v96, v96, v40
  v_mul_f32 v97, v97, v40
  v_mul_f32 v98, v98, v40
  v_mul_f32 v99, v99, v40
  v_mul_f32 v17, v96, v96
  v_mul_f32 v18, v97, v97
  v_mul_f32 v19, v98, v98
  v_mul_f32 v20, v99, v99
  v_fmaak_f32 v17, v46, v17, 3222493025
  v_fmaak_f32 v18, v46, v18, 3222493025
  v_fmaak_f32 v19, v46, v19, 3222493025
  v_fmaak_f32 v20, v46, v20, 3222493025
  v_mul_f32 v17, v17, v96
  v_mul_f32 v18, v18, v97
  v_mul_f32 v19, v19, v98
  v_mul_f32 v20, v20, v99
  v_exp_f32 v17, v17
  v_exp_f32 v18, v18
  v_exp_f32 v19, v19
  v_exp_f32 v20, v20
  v_mul_f32 v21, v96, v112
  v_mul_f32 v22, v97, v113
  v_mul_f32 v23, v98, v114
  v_mul_f32 v24, v99, v115
  v_add_f32 v17, 1.0, v17
  v_add_f32 v18, 1.0, v18
  v_add_f32 v19, 1.0, v19
  v_add_f32 v20, 1.0, v20
  v_rcp_f32 v17, v17
  v_rcp_f32 v18, v18
  v_rcp_f32 v19, v19
  v_rcp_f32 v20, v20
  v_mul_f32 v21, v21, v40
  v_mul_f32 v22, v22, v40
  v_mul_f32 v23, v23, v40
  v_mul_f32 v24, v24, v40
  v_mul_f32 v17, v17, v21
  v_mul_f32 v18, v18, v22
  v_mul_f32 v19, v19, v23
  v_mul_f32 v20, v20, v24
  v_cvt_pk_bf16_f32 v96, v17, v18
  v_cvt_pk_bf16_f32 v97, v19, v20
  v_mul_f32 v100, v100, v40
  v_mul_f32 v101, v101, v40
  v_mul_f32 v102, v102, v40
  v_mul_f32 v103, v103, v40
  v_mul_f32 v17, v100, v100
  v_mul_f32 v18, v101, v101
  v_mul_f32 v19, v102, v102
  v_mul_f32 v20, v103, v103
  v_fmaak_f32 v17, v46, v17, 3222493025
  v_fmaak_f32 v18, v46, v18, 3222493025
  v_fmaak_f32 v19, v46, v19, 3222493025
  v_fmaak_f32 v20, v46, v20, 3222493025
  v_mul_f32 v17, v17, v100
  v_mul_f32 v18, v18, v101
  v_mul_f32 v19, v19, v102
  v_mul_f32 v20, v20, v103
  v_exp_f32 v17, v17
  v_exp_f32 v18, v18
  v_exp_f32 v19, v19
  v_exp_f32 v20, v20
  v_mul_f32 v21, v100, v116
  v_mul_f32 v22, v101, v117
  v_mul_f32 v23, v102, v118
  v_mul_f32 v24, v103, v119
  v_add_f32 v17, 1.0, v17
  v_add_f32 v18, 1.0, v18
  v_add_f32 v19, 1.0, v19
  v_add_f32 v20, 1.0, v20
  v_rcp_f32 v17, v17
  v_rcp_f32 v18, v18
  v_rcp_f32 v19, v19
  v_rcp_f32 v20, v20
  v_mul_f32 v21, v21, v40
  v_mul_f32 v22, v22, v40
  v_mul_f32 v23, v23, v40
  v_mul_f32 v24, v24, v40
  v_mul_f32 v17, v17, v21
  v_mul_f32 v18, v18, v22
  v_mul_f32 v19, v19, v23
  v_mul_f32 v20, v20, v24
  v_cvt_pk_bf16_f32 v98, v17, v18
  v_cvt_pk_bf16_f32 v99, v19, v20
  v_mul_f32 v104, v104, v40
  v_mul_f32 v105, v105, v40
  v_mul_f32 v106, v106, v40
  v_mul_f32 v107, v107, v40
  v_mul_f32 v17, v104, v104
  v_mul_f32 v18, v105, v105
  v_mul_f32 v19, v106, v106
  v_mul_f32 v20, v107, v107
  v_fmaak_f32 v17, v46, v17, 3222493025
  v_fmaak_f32 v18, v46, v18, 3222493025
  v_fmaak_f32 v19, v46, v19, 3222493025
  v_fmaak_f32 v20, v46, v20, 3222493025
  v_mul_f32 v17, v17, v104
  v_mul_f32 v18, v18, v105
  v_mul_f32 v19, v19, v106
  v_mul_f32 v20, v20, v107
  v_exp_f32 v17, v17
  v_exp_f32 v18, v18
  v_exp_f32 v19, v19
  v_exp_f32 v20, v20
  v_mul_f32 v21, v104, v120
  v_mul_f32 v22, v105, v121
  v_mul_f32 v23, v106, v122
  v_mul_f32 v24, v107, v123
  v_add_f32 v17, 1.0, v17
  v_add_f32 v18, 1.0, v18
  v_add_f32 v19, 1.0, v19
  v_add_f32 v20, 1.0, v20
  v_rcp_f32 v17, v17
  v_rcp_f32 v18, v18
  v_rcp_f32 v19, v19
  v_rcp_f32 v20, v20
  v_mul_f32 v21, v21, v40
  v_mul_f32 v22, v22, v40
  v_mul_f32 v23, v23, v40
  v_mul_f32 v24, v24, v40
  v_mul_f32 v17, v17, v21
  v_mul_f32 v18, v18, v22
  v_mul_f32 v19, v19, v23
  v_mul_f32 v20, v20, v24
  v_cvt_pk_bf16_f32 v100, v17, v18
  v_cvt_pk_bf16_f32 v101, v19, v20
  v_mul_f32 v108, v108, v40
  v_mul_f32 v109, v109, v40
  v_mul_f32 v110, v110, v40
  v_mul_f32 v111, v111, v40
  v_mul_f32 v17, v108, v108
  v_mul_f32 v18, v109, v109
  v_mul_f32 v19, v110, v110
  v_mul_f32 v20, v111, v111
  v_fmaak_f32 v17, v46, v17, 3222493025
  v_fmaak_f32 v18, v46, v18, 3222493025
  v_fmaak_f32 v19, v46, v19, 3222493025
  v_fmaak_f32 v20, v46, v20, 3222493025
  v_mul_f32 v17, v17, v108
  v_mul_f32 v18, v18, v109
  v_mul_f32 v19, v19, v110
  v_mul_f32 v20, v20, v111
  v_exp_f32 v17, v17
  v_exp_f32 v18, v18
  v_exp_f32 v19, v19
  v_exp_f32 v20, v20
  v_mul_f32 v21, v108, v124
  v_mul_f32 v22, v109, v125
  v_mul_f32 v23, v110, v126
  v_mul_f32 v24, v111, v127
  v_add_f32 v17, 1.0, v17
  v_add_f32 v18, 1.0, v18
  v_add_f32 v19, 1.0, v19
  v_add_f32 v20, 1.0, v20
  v_rcp_f32 v17, v17
  v_rcp_f32 v18, v18
  v_rcp_f32 v19, v19
  v_rcp_f32 v20, v20
  v_mul_f32 v21, v21, v40
  v_mul_f32 v22, v22, v40
  v_mul_f32 v23, v23, v40
  v_mul_f32 v24, v24, v40
  v_mul_f32 v17, v17, v21
  v_mul_f32 v18, v18, v22
  v_mul_f32 v19, v19, v23
  v_mul_f32 v20, v20, v24
  v_cvt_pk_bf16_f32 v102, v17, v18
  v_cvt_pk_bf16_f32 v103, v19, v20
  v_lshlrev_b32 v17, 4, v1
  buffer_store_dwordx4 v[96:99], v17, s[16:19], s81 offen sc1
  buffer_store_dwordx4 v[100:103], v17, s[16:19], s81 offen offset:1024 sc1
U2S_79:
  s_add_u32 s77, s100, 0
  s_add_u32 m0, s89, 65536
  s_nop 0
  buffer_load_dwordx4 v44, s[24:27], s77 offen lds
  s_add_u32 s77, s100, 8192
  s_add_u32 m0, s89, 66560
  s_nop 0
  buffer_load_dwordx4 v45, s[24:27], s77 offen lds
  s_add_u32 s77, s100, 128
  s_add_u32 m0, s89, 81920
  s_nop 0
  buffer_load_dwordx4 v44, s[24:27], s77 offen lds
  s_add_u32 s77, s100, 8320
  s_add_u32 m0, s89, 82944
  s_nop 0
  buffer_load_dwordx4 v45, s[24:27], s77 offen lds
  s_add_u32 s77, s100, 256
  s_add_u32 m0, s89, 98304
  s_nop 0
  buffer_load_dwordx4 v44, s[24:27], s77 offen lds
  s_add_u32 s77, s100, 8448
  s_add_u32 m0, s89, 99328
  s_nop 0
  buffer_load_dwordx4 v45, s[24:27], s77 offen lds
  s_add_u32 s77, s100, 384
  s_add_u32 m0, s89, 114688
  s_nop 0
  buffer_load_dwordx4 v44, s[24:27], s77 offen lds
  s_add_u32 s77, s100, 8576
  s_add_u32 m0, s89, 115712
  s_nop 0
  buffer_load_dwordx4 v45, s[24:27], s77 offen lds
  s_waitcnt vmcnt(8)
  s_lshl_b32 s76, s38, 11
  s_lshl_b32 s77, s39, 5
  s_add_u32 s76, s76, s77
  s_lshl_b32 s77, s36, 2
  s_add_u32 s76, s76, s77
  s_add_u32 s76, s76, 11534848
  v_mov_b32 v26, 0
  v_mov_b32 v27, s75
  s_mov_b64 s[92:93], exec
  s_mov_b64 exec, 1
  buffer_store_dword v27, v26, s[16:19], s76 offen sc1
  s_mov_b64 exec, s[92:93]
  v_lshrrev_b32 v17, 5, v1
  v_lshlrev_b32 v17, 2, v17
  v_bfe_u32 v3, v1, 2, 2
  v_add_u32 v17, v17, v3
  v_lshlrev_b32 v17, 7, v17
  v_bfe_u32 v3, v1, 3, 1
  v_lshl_add_u32 v17, v3, 6, v17
  v_bfe_u32 v3, v1, 4, 1
  v_lshl_add_u32 v17, v3, 5, v17
  v_and_b32 v3, 3, v1
  v_lshl_add_u32 v17, v3, 3, v17
  s_lshl_b32 s76, s37, 12
  v_add_u32 v4, s76, v17
  v_xor_b32 v5, 64, v4
  v_and_b32 v17, 31, v1
  v_bfe_u32 v3, v17, 1, 3
  v_lshrrev_b32 v18, 5, v1
  s_lshr_b32 s76, s37, 1
  s_lshl_b32 s76, s76, 2
  v_add_u32 v18, s76, v18
  v_xor_b32 v3, v3, v18
  v_lshlrev_b32 v17, 7, v17
  v_lshl_add_u32 v17, v3, 4, v17
  s_and_b32 s76, s37, 1
  s_lshl_b32 s76, s76, 13
  v_add_u32 v6, s76, v17
  v_xor_b32 v7, 32, v6
  v_lshrrev_b32 v17, 5, v1
  v_lshlrev_b32 v17, 4, v17
  s_lshl_b32 s76, s87, 6
  s_lshl_b32 s77, s37, 2
  s_add_u32 s76, s76, s77
  s_add_u32 s76, s76, 32
  v_add_u32 v17, s76, v17
  v_lshlrev_b32 v11, 4, v17
  v_lshlrev_b32 v17, 9, v17
  v_and_b32 v3, 31, v1
  s_lshl_b32 s76, s88, 6
  v_add_u32 v3, s76, v3
  v_add_u32 v17, v17, v3
  v_lshlrev_b32 v9, 1, v17
  v_lshlrev_b32 v12, 1, v3
  v_mov_b32 v208, 0
  v_mov_b32 v209, 0
  v_mov_b32 v210, 0
  v_mov_b32 v211, 0
  v_mov_b32 v212, 0
  v_mov_b32 v213, 0
  v_mov_b32 v214, 0
  v_mov_b32 v215, 0
  v_mov_b32 v216, 0
  v_mov_b32 v217, 0
  v_mov_b32 v218, 0
  v_mov_b32 v219, 0
  v_mov_b32 v220, 0
  v_mov_b32 v221, 0
  v_mov_b32 v222, 0
  v_mov_b32 v223, 0
  v_mov_b32 v224, 0
  v_mov_b32 v225, 0
  v_mov_b32 v226, 0
  v_mov_b32 v227, 0
  v_mov_b32 v228, 0
  v_mov_b32 v229, 0
  v_mov_b32 v230, 0
  v_mov_b32 v231, 0
  v_mov_b32 v232, 0
  v_mov_b32 v233, 0
  v_mov_b32 v234, 0
  v_mov_b32 v235, 0
  v_mov_b32 v236, 0
  v_mov_b32 v237, 0
  v_mov_b32 v238, 0
  v_mov_b32 v239, 0
  buffer_load_ushort v8, v12, s[32:35], 0 offen
  buffer_load_ushort v10, v12, s[32:35], 0 offen offset:64
  buffer_load_ushort v104, v9, s[4:7], 0 offen offset:0
  buffer_load_ushort v105, v9, s[4:7], 0 offen offset:1024
  buffer_load_ushort v106, v9, s[4:7], 0 offen offset:2048
  buffer_load_ushort v107, v9, s[4:7], 0 offen offset:3072
  buffer_load_ushort v108, v9, s[4:7], 0 offen offset:64
  buffer_load_ushort v109, v9, s[4:7], 0 offen offset:1088
  buffer_load_ushort v110, v9, s[4:7], 0 offen offset:2112
  buffer_load_ushort v111, v9, s[4:7], 0 offen offset:3136
  s_mov_b32 s76, 10747904
  buffer_load_dword v112, v11, s[16:19], s76 offen offset:0 sc1
  buffer_load_dword v116, v11, s[16:19], s76 offen offset:8 sc1
  buffer_load_dword v113, v11, s[16:19], s76 offen offset:16 sc1
  buffer_load_dword v117, v11, s[16:19], s76 offen offset:24 sc1
  buffer_load_dword v114, v11, s[16:19], s76 offen offset:32 sc1
  buffer_load_dword v118, v11, s[16:19], s76 offen offset:40 sc1
  buffer_load_dword v115, v11, s[16:19], s76 offen offset:48 sc1
  buffer_load_dword v119, v11, s[16:19], s76 offen offset:56 sc1
  s_barrier
  ds_read_b64_tr_b16 v[176:177], v4 offset:0
  ds_read_b64_tr_b16 v[178:179], v4 offset:1024
  ds_read_b64_tr_b16 v[180:181], v5 offset:0
  ds_read_b64_tr_b16 v[182:183], v5 offset:1024
  ds_read_b64_tr_b16 v[184:185], v4 offset:2048
  ds_read_b64_tr_b16 v[186:187], v4 offset:3072
  ds_read_b64_tr_b16 v[188:189], v5 offset:2048
  ds_read_b64_tr_b16 v[190:191], v5 offset:3072
  s_barrier
  s_waitcnt vmcnt(33)
  s_waitcnt lgkmcnt(6)
  v_mfma_f32_32x32x16_bf16 v[208:223], v[128:131], v[176:179], v[208:223]
  ds_read_b64_tr_b16 v[192:193], v4 offset:16384
  ds_read_b64_tr_b16 v[194:195], v4 offset:17408
  s_waitcnt lgkmcnt(6)
  v_mfma_f32_32x32x16_bf16 v[224:239], v[128:131], v[180:183], v[224:239]
  ds_read_b64_tr_b16 v[196:197], v5 offset:16384
  ds_read_b64_tr_b16 v[198:199], v5 offset:17408
  s_waitcnt lgkmcnt(6)
  v_mfma_f32_32x32x16_bf16 v[208:223], v[132:135], v[184:187], v[208:223]
  ds_read_b64_tr_b16 v[200:201], v4 offset:18432
  ds_read_b64_tr_b16 v[202:203], v4 offset:19456
  s_waitcnt lgkmcnt(6)
  v_mfma_f32_32x32x16_bf16 v[224:239], v[132:135], v[188:191], v[224:239]
  ds_read_b64_tr_b16 v[204:205], v5 offset:18432
  ds_read_b64_tr_b16 v[206:207], v5 offset:19456
  s_barrier
  s_waitcnt vmcnt(31)
  s_waitcnt lgkmcnt(6)
  v_mfma_f32_32x32x16_bf16 v[208:223], v[136:139], v[192:195], v[208:223]
  ds_read_b64_tr_b16 v[176:177], v4 offset:32768
  ds_read_b64_tr_b16 v[178:179], v4 offset:33792
  s_add_u32 s77, s100, 512
  s_add_u32 m0, s89, 0
  s_nop 0
  buffer_load_dwordx4 v44, s[24:27], s77 offen lds
  s_waitcnt lgkmcnt(6)
  v_mfma_f32_32x32x16_bf16 v[224:239], v[136:139], v[196:199], v[224:239]
  ds_read_b64_tr_b16 v[180:181], v5 offset:32768
  ds_read_b64_tr_b16 v[182:183], v5 offset:33792
  s_add_u32 s77, s100, 8704
  s_add_u32 m0, s89, 1024
  s_nop 0
  buffer_load_dwordx4 v45, s[24:27], s77 offen lds
  s_waitcnt lgkmcnt(6)
  v_mfma_f32_32x32x16_bf16 v[208:223], v[140:143], v[200:203], v[208:223]
  ds_read_b64_tr_b16 v[184:185], v4 offset:34816
  ds_read_b64_tr_b16 v[186:187], v4 offset:35840
  s_waitcnt lgkmcnt(6)
  v_mfma_f32_32x32x16_bf16 v[224:239], v[140:143], v[204:207], v[224:239]
  ds_read_b64_tr_b16 v[188:189], v5 offset:34816
  ds_read_b64_tr_b16 v[190:191], v5 offset:35840
  s_barrier
  s_waitcnt vmcnt(31)
  s_waitcnt lgkmcnt(6)
  v_mfma_f32_32x32x16_bf16 v[208:223], v[144:147], v[176:179], v[208:223]
  ds_read_b64_tr_b16 v[192:193], v4 offset:49152
  ds_read_b64_tr_b16 v[194:195], v4 offset:50176
  s_mov_b32 s77, 88064
  buffer_load_dwordx4 v[160:163], v42, s[16:19], s77 offen sc1
  buffer_load_dwordx4 v[164:167], v42, s[16:19], s77 offen offset:1024 sc1
  s_waitcnt lgkmcnt(6)
  v_mfma_f32_32x32x16_bf16 v[224:239], v[144:147], v[180:183], v[224:239]
  ds_read_b64_tr_b16 v[196:197], v5 offset:49152
  ds_read_b64_tr_b16 v[198:199], v5 offset:50176
  s_mov_b32 s77, 96256
  buffer_load_dwordx4 v[168:171], v42, s[16:19], s77 offen sc1
  buffer_load_dwordx4 v[172:175], v42, s[16:19], s77 offen offset:1024 sc1
  s_waitcnt lgkmcnt(6)
  v_mfma_f32_32x32x16_bf16 v[208:223], v[148:151], v[184:187], v[208:223]
  ds_read_b64_tr_b16 v[200:201], v4 offset:51200
  ds_read_b64_tr_b16 v[202:203], v4 offset:52224
  s_mov_b32 s77, 104448
  buffer_load_dwordx4 v[64:67], v42, s[16:19], s77 offen sc1
  buffer_load_dwordx4 v[68:71], v42, s[16:19], s77 offen offset:1024 sc1
  s_waitcnt lgkmcnt(6)
  v_mfma_f32_32x32x16_bf16 v[224:239], v[148:151], v[188:191], v[224:239]
  ds_read_b64_tr_b16 v[204:205], v5 offset:51200
  ds_read_b64_tr_b16 v[206:207], v5 offset:52224
  s_add_u32 s77, s100, 640
  s_add_u32 m0, s89, 16384
  s_nop 0
  buffer_load_dwordx4 v44, s[24:27], s77 offen lds
  s_add_u32 s77, s100, 8832
  s_add_u32 m0, s89, 17408
  s_nop 0
  buffer_load_dwordx4 v45, s[24:27], s77 offen lds
  s_waitcnt vmcnt(35)
  s_barrier
  s_waitcnt lgkmcnt(6)
  v_mfma_f32_32x32x16_bf16 v[208:223], v[152:155], v[192:195], v[208:223]
  v_xor_b32 v4, 0x10000, v4
  v_xor_b32 v5, 0x10000, v5
  v_xor_b32 v6, 0x10000, v6
  v_xor_b32 v7, 0x10000, v7
  ds_read_b128 v[176:179], v6 offset:0
  s_mov_b32 s77, 112640
  buffer_load_dwordx4 v[72:75], v42, s[16:19], s77 offen sc1
  buffer_load_dwordx4 v[76:79], v42, s[16:19], s77 offen offset:1024 sc1
  s_waitcnt lgkmcnt(5)
  v_mfma_f32_32x32x16_bf16 v[224:239], v[152:155], v[196:199], v[224:239]
  ds_read_b128 v[180:183], v6 offset:4096
  s_mov_b32 s77, 120832
  buffer_load_dwordx4 v[80:83], v42, s[16:19], s77 offen sc1
  buffer_load_dwordx4 v[84:87], v42, s[16:19], s77 offen offset:1024 sc1
  s_waitcnt lgkmcnt(4)
  v_mfma_f32_32x32x16_bf16 v[208:223], v[156:159], v[200:203], v[208:223]
  ds_read_b128 v[184:187], v7 offset:0
  s_mov_b32 s77, 129024
  buffer_load_dwordx4 v[88:91], v42, s[16:19], s77 offen sc1
  buffer_load_dwordx4 v[92:95], v42, s[16:19], s77 offen offset:1024 sc1
  s_waitcnt lgkmcnt(3)
  v_mfma_f32_32x32x16_bf16 v[224:239], v[156:159], v[204:207], v[224:239]
  ds_read_b128 v[188:191], v7 offset:4096
  s_add_u32 s77, s100, 768
  s_add_u32 m0, s89, 32768
  s_nop 0
  buffer_load_dwordx4 v44, s[24:27], s77 offen lds
  s_add_u32 s77, s100, 8960
  s_add_u32 m0, s89, 33792
  s_nop 0
  buffer_load_dwordx4 v45, s[24:27], s77 offen lds
  s_waitcnt vmcnt(41)
  s_barrier
  s_waitcnt vmcnt(14)
  s_waitcnt lgkmcnt(3)
  v_mfma_f32_32x32x16_bf16 v[208:223], v[160:163], v[176:179], v[208:223]
  ds_read_b128 v[192:195], v6 offset:16384
  s_mov_b32 s77, 137216
  buffer_load_dwordx4 v[128:131], v42, s[16:19], s77 offen sc1
  buffer_load_dwordx4 v[132:135], v42, s[16:19], s77 offen offset:1024 sc1
  s_waitcnt lgkmcnt(3)
  v_mfma_f32_32x32x16_bf16 v[224:239], v[160:163], v[180:183], v[224:239]
  ds_read_b128 v[196:199], v6 offset:20480
  s_mov_b32 s77, 145408
  buffer_load_dwordx4 v[136:139], v42, s[16:19], s77 offen sc1
  buffer_load_dwordx4 v[140:143], v42, s[16:19], s77 offen offset:1024 sc1
  s_waitcnt lgkmcnt(3)
  v_mfma_f32_32x32x16_bf16 v[208:223], v[164:167], v[184:187], v[208:223]
  ds_read_b128 v[200:203], v7 offset:16384
  s_add_u32 s77, s100, 896
  s_add_u32 m0, s89, 49152
  s_nop 0
  buffer_load_dwordx4 v44, s[24:27], s77 offen lds
  s_add_u32 s77, s100, 9088
  s_add_u32 m0, s89, 50176
  s_nop 0
  buffer_load_dwordx4 v45, s[24:27], s77 offen lds
  s_waitcnt lgkmcnt(3)
  v_mfma_f32_32x32x16_bf16 v[224:239], v[164:167], v[188:191], v[224:239]
  ds_read_b128 v[204:207], v7 offset:20480
  s_barrier
  s_waitcnt vmcnt(18)
  s_waitcnt lgkmcnt(3)
  v_mfma_f32_32x32x16_bf16 v[208:223], v[168:171], v[192:195], v[208:223]
  ds_read_b128 v[176:179], v6 offset:32768
  s_mov_b32 s77, 32768
  buffer_load_dwordx4 v[144:147], v42, s[16:19], s77 offen sc1
  s_waitcnt lgkmcnt(3)
  v_mfma_f32_32x32x16_bf16 v[224:239], v[168:171], v[196:199], v[224:239]
  ds_read_b128 v[180:183], v6 offset:36864
  buffer_load_dwordx4 v[148:151], v42, s[16:19], s77 offen offset:1024 sc1
  s_waitcnt lgkmcnt(3)
  v_mfma_f32_32x32x16_bf16 v[208:223], v[172:175], v[200:203], v[208:223]
  ds_read_b128 v[184:187], v7 offset:32768
  s_add_u32 s77, s98, 32768
  s_add_u32 m0, s89, 65536
  s_nop 0
  buffer_load_dwordx4 v43, s[20:23], s77 offen lds
  s_waitcnt lgkmcnt(3)
  v_mfma_f32_32x32x16_bf16 v[224:239], v[172:175], v[204:207], v[224:239]
  ds_read_b128 v[188:191], v7 offset:36864
  s_add_u32 s77, s98, 40960
  s_add_u32 m0, s89, 66560
  s_nop 0
  buffer_load_dwordx4 v43, s[20:23], s77 offen lds
  s_barrier
  s_waitcnt vmcnt(20)
  s_waitcnt lgkmcnt(3)
  v_mfma_f32_32x32x16_bf16 v[208:223], v[64:67], v[176:179], v[208:223]
  ds_read_b128 v[192:195], v6 offset:49152
  s_mov_b32 s77, 40960
  buffer_load_dwordx4 v[152:155], v42, s[16:19], s77 offen sc1
  s_waitcnt lgkmcnt(3)
  v_mfma_f32_32x32x16_bf16 v[224:239], v[64:67], v[180:183], v[224:239]
  ds_read_b128 v[196:199], v6 offset:53248
  buffer_load_dwordx4 v[156:159], v42, s[16:19], s77 offen offset:1024 sc1
  s_waitcnt lgkmcnt(3)
  v_mfma_f32_32x32x16_bf16 v[208:223], v[68:71], v[184:187], v[208:223]
  ds_read_b128 v[200:203], v7 offset:49152
  s_add_u32 s77, s98, 425984
  s_add_u32 m0, s89, 81920
  s_nop 0
  buffer_load_dwordx4 v43, s[20:23], s77 offen lds
  s_waitcnt lgkmcnt(3)
  v_mfma_f32_32x32x16_bf16 v[224:239], v[68:71], v[188:191], v[224:239]
  ds_read_b128 v[204:207], v7 offset:53248
  s_add_u32 s77, s98, 434176
  s_add_u32 m0, s89, 82944
  s_nop 0
  buffer_load_dwordx4 v43, s[20:23], s77 offen lds
  s_barrier
  s_waitcnt vmcnt(20)
  s_waitcnt lgkmcnt(3)
  v_mfma_f32_32x32x16_bf16 v[208:223], v[72:75], v[192:195], v[208:223]
  v_xor_b32 v4, 0x10000, v4
  v_xor_b32 v5, 0x10000, v5
  v_xor_b32 v6, 0x10000, v6
  v_xor_b32 v7, 0x10000, v7
  ds_read_b128 v[176:179], v6 offset:0
  s_mov_b32 s77, 49152
  buffer_load_dwordx4 v[160:163], v42, s[16:19], s77 offen sc1
  s_waitcnt lgkmcnt(3)
  v_mfma_f32_32x32x16_bf16 v[224:239], v[72:75], v[196:199], v[224:239]
  ds_read_b128 v[180:183], v6 offset:4096
  buffer_load_dwordx4 v[164:167], v42, s[16:19], s77 offen offset:1024 sc1
  s_waitcnt lgkmcnt(3)
  v_mfma_f32_32x32x16_bf16 v[208:223], v[76:79], v[200:203], v[208:223]
  ds_read_b128 v[184:187], v7 offset:0
  s_add_u32 s77, s98, 819200
  s_add_u32 m0, s89, 98304
  s_nop 0
  buffer_load_dwordx4 v43, s[20:23], s77 offen lds
  s_waitcnt lgkmcnt(3)
  v_mfma_f32_32x32x16_bf16 v[224:239], v[76:79], v[204:207], v[224:239]
  ds_read_b128 v[188:191], v7 offset:4096
  s_add_u32 s77, s98, 827392
  s_add_u32 m0, s89, 99328
  s_nop 0
  buffer_load_dwordx4 v43, s[20:23], s77 offen lds
  s_barrier
  s_waitcnt vmcnt(22)
  s_waitcnt lgkmcnt(3)
  v_mfma_f32_32x32x16_bf16 v[208:223], v[80:83], v[176:179], v[208:223]
  ds_read_b128 v[192:195], v6 offset:16384
  s_mov_b32 s77, 57344
  buffer_load_dwordx4 v[168:171], v42, s[16:19], s77 offen sc1
  s_waitcnt lgkmcnt(3)
  v_mfma_f32_32x32x16_bf16 v[224:239], v[80:83], v[180:183], v[224:239]
  ds_read_b128 v[196:199], v6 offset:20480
  buffer_load_dwordx4 v[172:175], v42, s[16:19], s77 offen offset:1024 sc1
  s_waitcnt lgkmcnt(3)
  v_mfma_f32_32x32x16_bf16 v[208:223], v[84:87], v[184:187], v[208:223]
  ds_read_b128 v[200:203], v7 offset:16384
  s_add_u32 s77, s99, 1179648
  s_add_u32 m0, s89, 114688
  s_nop 0
  buffer_load_dwordx4 v43, s[20:23], s77 offen lds
  s_waitcnt lgkmcnt(3)
  v_mfma_f32_32x32x16_bf16 v[224:239], v[84:87], v[188:191], v[224:239]
  ds_read_b128 v[204:207], v7 offset:20480
  s_add_u32 s77, s99, 1187840
  s_add_u32 m0, s89, 115712
  s_nop 0
  buffer_load_dwordx4 v43, s[20:23], s77 offen lds
  s_waitcnt vmcnt(22)
  s_barrier
  s_waitcnt lgkmcnt(3)
  v_mfma_f32_32x32x16_bf16 v[208:223], v[88:91], v[192:195], v[208:223]
  ds_read_b128 v[176:179], v6 offset:32768
  s_mov_b32 s77, 65536
  buffer_load_dwordx4 v[64:67], v42, s[16:19], s77 offen sc1
  s_waitcnt lgkmcnt(3)
  v_mfma_f32_32x32x16_bf16 v[224:239], v[88:91], v[196:199], v[224:239]
  ds_read_b128 v[180:183], v6 offset:36864
  buffer_load_dwordx4 v[68:71], v42, s[16:19], s77 offen offset:1024 sc1
  s_waitcnt lgkmcnt(3)
  v_mfma_f32_32x32x16_bf16 v[208:223], v[92:95], v[200:203], v[208:223]
  ds_read_b128 v[184:187], v7 offset:32768
  s_add_u32 s77, s98, 65536
  s_add_u32 m0, s89, 0
  s_nop 0
  buffer_load_dwordx4 v43, s[20:23], s77 offen lds
  s_waitcnt lgkmcnt(3)
  v_mfma_f32_32x32x16_bf16 v[224:239], v[92:95], v[204:207], v[224:239]
  ds_read_b128 v[188:191], v7 offset:36864
  s_add_u32 s77, s98, 73728
  s_add_u32 m0, s89, 1024
  s_nop 0
  buffer_load_dwordx4 v43, s[20:23], s77 offen lds
  s_waitcnt vmcnt(20)
  s_barrier
  s_waitcnt lgkmcnt(3)
  v_mfma_f32_32x32x16_bf16 v[208:223], v[128:131], v[176:179], v[208:223]
  ds_read_b128 v[192:195], v6 offset:49152
  s_mov_b32 s77, 73728
  buffer_load_dwordx4 v[72:75], v42, s[16:19], s77 offen sc1
  s_waitcnt lgkmcnt(3)
  v_mfma_f32_32x32x16_bf16 v[224:239], v[128:131], v[180:183], v[224:239]
  ds_read_b128 v[196:199], v6 offset:53248
  buffer_load_dwordx4 v[76:79], v42, s[16:19], s77 offen offset:1024 sc1
  s_waitcnt lgkmcnt(3)
  v_mfma_f32_32x32x16_bf16 v[208:223], v[132:135], v[184:187], v[208:223]
  ds_read_b128 v[200:203], v7 offset:49152
  s_add_u32 s77, s98, 458752
  s_add_u32 m0, s89, 16384
  s_nop 0
  buffer_load_dwordx4 v43, s[20:23], s77 offen lds
  s_waitcnt lgkmcnt(3)
  v_mfma_f32_32x32x16_bf16 v[224:239], v[132:135], v[188:191], v[224:239]
  ds_read_b128 v[204:207], v7 offset:53248
  s_add_u32 s77, s98, 466944
  s_add_u32 m0, s89, 17408
  s_nop 0
  buffer_load_dwordx4 v43, s[20:23], s77 offen lds
  s_waitcnt vmcnt(20)
  s_barrier
  s_waitcnt lgkmcnt(3)
  v_mfma_f32_32x32x16_bf16 v[208:223], v[136:139], v[192:195], v[208:223]
  v_xor_b32 v4, 0x10000, v4
  v_xor_b32 v5, 0x10000, v5
  v_xor_b32 v6, 0x10000, v6
  v_xor_b32 v7, 0x10000, v7
  ds_read_b64_tr_b16 v[176:177], v4 offset:0
  ds_read_b64_tr_b16 v[178:179], v4 offset:1024
  s_mov_b32 s77, 81920
  s_cmp_eq_u32 s37, 3
  s_cselect_b32 s77, 79872, s77
  buffer_load_dwordx4 v[80:83], v42, s[16:19], s77 offen sc1
  s_waitcnt lgkmcnt(4)
  v_mfma_f32_32x32x16_bf16 v[224:239], v[136:139], v[196:199], v[224:239]
  ds_read_b64_tr_b16 v[180:181], v5 offset:0
  ds_read_b64_tr_b16 v[182:183], v5 offset:1024
  buffer_load_dwordx4 v[84:87], v42, s[16:19], s77 offen offset:1024 sc1
  s_waitcnt lgkmcnt(5)
  v_mfma_f32_32x32x16_bf16 v[208:223], v[140:143], v[200:203], v[208:223]
  ds_read_b64_tr_b16 v[184:185], v4 offset:2048
  ds_read_b64_tr_b16 v[186:187], v4 offset:3072
  s_add_u32 s77, s96, 851968
  s_add_u32 m0, s89, 32768
  s_nop 0
  buffer_load_dwordx4 v43, s[20:23], s77 offen lds
  s_waitcnt lgkmcnt(6)
  v_mfma_f32_32x32x16_bf16 v[224:239], v[140:143], v[204:207], v[224:239]
  ds_read_b64_tr_b16 v[188:189], v5 offset:2048
  ds_read_b64_tr_b16 v[190:191], v5 offset:3072
  s_add_u32 s77, s96, 860160
  s_add_u32 m0, s89, 33792
  s_nop 0
  buffer_load_dwordx4 v43, s[20:23], s77 offen lds
  s_waitcnt vmcnt(20)
  s_barrier
  s_waitcnt lgkmcnt(6)
  v_mfma_f32_32x32x16_bf16 v[208:223], v[144:147], v[176:179], v[208:223]
  ds_read_b64_tr_b16 v[192:193], v4 offset:16384
  ds_read_b64_tr_b16 v[194:195], v4 offset:17408
  s_waitcnt lgkmcnt(6)
  v_mfma_f32_32x32x16_bf16 v[224:239], v[144:147], v[180:183], v[224:239]
  ds_read_b64_tr_b16 v[196:197], v5 offset:16384
  ds_read_b64_tr_b16 v[198:199], v5 offset:17408
  s_waitcnt lgkmcnt(6)
  v_mfma_f32_32x32x16_bf16 v[208:223], v[148:151], v[184:187], v[208:223]
  ds_read_b64_tr_b16 v[200:201], v4 offset:18432
  ds_read_b64_tr_b16 v[202:203], v4 offset:19456
  s_waitcnt lgkmcnt(6)
  v_mfma_f32_32x32x16_bf16 v[224:239], v[148:151], v[188:191], v[224:239]
  ds_read_b64_tr_b16 v[204:205], v5 offset:18432
  ds_read_b64_tr_b16 v[206:207], v5 offset:19456
  s_waitcnt vmcnt(16)
  s_barrier
  s_waitcnt lgkmcnt(6)
  v_mfma_f32_32x32x16_bf16 v[208:223], v[152:155], v[192:195], v[208:223]
  ds_read_b64_tr_b16 v[176:177], v4 offset:32768
  ds_read_b64_tr_b16 v[178:179], v4 offset:33792
  s_waitcnt lgkmcnt(6)
  v_mfma_f32_32x32x16_bf16 v[224:239], v[152:155], v[196:199], v[224:239]
  ds_read_b64_tr_b16 v[180:181], v5 offset:32768
  ds_read_b64_tr_b16 v[182:183], v5 offset:33792
  s_waitcnt lgkmcnt(6)
  v_mfma_f32_32x32x16_bf16 v[208:223], v[156:159], v[200:203], v[208:223]
  ds_read_b64_tr_b16 v[184:185], v4 offset:34816
  ds_read_b64_tr_b16 v[186:187], v4 offset:35840
  s_waitcnt lgkmcnt(6)
  v_mfma_f32_32x32x16_bf16 v[224:239], v[156:159], v[204:207], v[224:239]
  ds_read_b64_tr_b16 v[188:189], v5 offset:34816
  ds_read_b64_tr_b16 v[190:191], v5 offset:35840
  v_lshlrev_b32 v8, 16, v8
  v_lshlrev_b32 v10, 16, v10
  v_lshlrev_b32 v9, 1, v9
  v_rcp_f32 v116, v116
  v_rcp_f32 v117, v117
  v_rcp_f32 v118, v118
  v_rcp_f32 v119, v119
  v_lshlrev_b32 v104, 16, v104
  v_lshlrev_b32 v105, 16, v105
  v_lshlrev_b32 v106, 16, v106
  v_lshlrev_b32 v107, 16, v107
  v_lshlrev_b32 v108, 16, v108
  v_lshlrev_b32 v109, 16, v109
  v_lshlrev_b32 v110, 16, v110
  v_lshlrev_b32 v111, 16, v111
  v_sub_f32 v120, v104, v112
  v_sub_f32 v121, v105, v113
  v_sub_f32 v122, v106, v114
  v_sub_f32 v123, v107, v115
  v_sub_f32 v124, v108, v112
  v_sub_f32 v125, v109, v113
  v_sub_f32 v126, v110, v114
  v_sub_f32 v127, v111, v115
  v_cvt_pk_bf16_f32 v18, v120, v121
  v_lshlrev_b32 v120, 16, v18
  v_and_b32 v121, 0xffff0000, v18
  v_cvt_pk_bf16_f32 v18, v122, v123
  v_lshlrev_b32 v122, 16, v18
  v_and_b32 v123, 0xffff0000, v18
  v_cvt_pk_bf16_f32 v18, v124, v125
  v_lshlrev_b32 v124, 16, v18
  v_and_b32 v125, 0xffff0000, v18
  v_cvt_pk_bf16_f32 v18, v126, v127
  v_lshlrev_b32 v126, 16, v18
  v_and_b32 v127, 0xffff0000, v18
  v_mul_f32 v120, v120, v116
  v_mul_f32 v121, v121, v117
  v_mul_f32 v122, v122, v118
  v_mul_f32 v123, v123, v119
  v_mul_f32 v124, v124, v116
  v_mul_f32 v125, v125, v117
  v_mul_f32 v126, v126, v118
  v_mul_f32 v127, v127, v119
  v_cvt_pk_bf16_f32 v18, v120, v121
  v_lshlrev_b32 v120, 16, v18
  v_and_b32 v121, 0xffff0000, v18
  v_cvt_pk_bf16_f32 v18, v122, v123
  v_lshlrev_b32 v122, 16, v18
  v_and_b32 v123, 0xffff0000, v18
  v_cvt_pk_bf16_f32 v18, v124, v125
  v_lshlrev_b32 v124, 16, v18
  v_and_b32 v125, 0xffff0000, v18
  v_cvt_pk_bf16_f32 v18, v126, v127
  v_lshlrev_b32 v126, 16, v18
  v_and_b32 v127, 0xffff0000, v18
  v_mul_f32 v120, v120, v8
  v_mul_f32 v121, v121, v8
  v_mul_f32 v122, v122, v8
  v_mul_f32 v123, v123, v8
  v_mul_f32 v124, v124, v10
  v_mul_f32 v125, v125, v10
  v_mul_f32 v126, v126, v10
  v_mul_f32 v127, v127, v10
  v_cvt_pk_bf16_f32 v18, v120, v121
  v_lshlrev_b32 v120, 16, v18
  v_and_b32 v121, 0xffff0000, v18
  v_cvt_pk_bf16_f32 v18, v122, v123
  v_lshlrev_b32 v122, 16, v18
  v_and_b32 v123, 0xffff0000, v18
  v_cvt_pk_bf16_f32 v18, v124, v125
  v_lshlrev_b32 v124, 16, v18
  v_and_b32 v125, 0xffff0000, v18
  v_cvt_pk_bf16_f32 v18, v126, v127
  v_lshlrev_b32 v126, 16, v18
  v_and_b32 v127, 0xffff0000, v18
  v_add_f32 v120, v120, v104
  v_add_f32 v121, v121, v105
  v_add_f32 v122, v122, v106
  v_add_f32 v123, v123, v107
  v_add_f32 v124, v124, v108
  v_add_f32 v125, v125, v109
  v_add_f32 v126, v126, v110
  v_add_f32 v127, v127, v111
  s_waitcnt vmcnt(12)
  s_barrier
  s_waitcnt lgkmcnt(6)
  v_mfma_f32_32x32x16_bf16 v[208:223], v[160:163], v[176:179], v[208:223]
  ds_read_b64_tr_b16 v[192:193], v4 offset:49152
  ds_read_b64_tr_b16 v[194:195], v4 offset:50176
  s_waitcnt lgkmcnt(6)
  v_mfma_f32_32x32x16_bf16 v[224:239], v[160:163], v[180:183], v[224:239]
  ds_read_b64_tr_b16 v[196:197], v5 offset:49152
  ds_read_b64_tr_b16 v[198:199], v5 offset:50176
  s_waitcnt lgkmcnt(6)
  v_mfma_f32_32x32x16_bf16 v[208:223], v[164:167], v[184:187], v[208:223]
  ds_read_b64_tr_b16 v[200:201], v4 offset:51200
  ds_read_b64_tr_b16 v[202:203], v4 offset:52224
  s_waitcnt lgkmcnt(6)
  v_mfma_f32_32x32x16_bf16 v[224:239], v[164:167], v[188:191], v[224:239]
  ds_read_b64_tr_b16 v[204:205], v5 offset:51200
  ds_read_b64_tr_b16 v[206:207], v5 offset:52224
  s_waitcnt vmcnt(8)
  s_barrier
  s_waitcnt lgkmcnt(6)
  v_mfma_f32_32x32x16_bf16 v[208:223], v[168:171], v[192:195], v[208:223]
  v_xor_b32 v4, 0x10000, v4
  v_xor_b32 v5, 0x10000, v5
  v_xor_b32 v6, 0x10000, v6
  v_xor_b32 v7, 0x10000, v7
  ds_read_b64_tr_b16 v[176:177], v4 offset:0
  ds_read_b64_tr_b16 v[178:179], v4 offset:1024
  s_waitcnt lgkmcnt(6)
  v_mfma_f32_32x32x16_bf16 v[224:239], v[168:171], v[196:199], v[224:239]
  ds_read_b64_tr_b16 v[180:181], v5 offset:0
  ds_read_b64_tr_b16 v[182:183], v5 offset:1024
  s_waitcnt lgkmcnt(6)
  v_mfma_f32_32x32x16_bf16 v[208:223], v[172:175], v[200:203], v[208:223]
  ds_read_b64_tr_b16 v[184:185], v4 offset:2048
  ds_read_b64_tr_b16 v[186:187], v4 offset:3072
  s_waitcnt lgkmcnt(6)
  v_mfma_f32_32x32x16_bf16 v[224:239], v[172:175], v[204:207], v[224:239]
  ds_read_b64_tr_b16 v[188:189], v5 offset:2048
  ds_read_b64_tr_b16 v[190:191], v5 offset:3072
  s_waitcnt vmcnt(4)
  s_barrier
  s_waitcnt lgkmcnt(6)
  v_mfma_f32_32x32x16_bf16 v[208:223], v[64:67], v[176:179], v[208:223]
  ds_read_b64_tr_b16 v[192:193], v4 offset:16384
  ds_read_b64_tr_b16 v[194:195], v4 offset:17408
  s_waitcnt lgkmcnt(6)
  v_mfma_f32_32x32x16_bf16 v[224:239], v[64:67], v[180:183], v[224:239]
  ds_read_b64_tr_b16 v[196:197], v5 offset:16384
  ds_read_b64_tr_b16 v[198:199], v5 offset:17408
  s_waitcnt lgkmcnt(6)
  v_mfma_f32_32x32x16_bf16 v[208:223], v[68:71], v[184:187], v[208:223]
  ds_read_b64_tr_b16 v[200:201], v4 offset:18432
  ds_read_b64_tr_b16 v[202:203], v4 offset:19456
  s_waitcnt lgkmcnt(6)
  v_mfma_f32_32x32x16_bf16 v[224:239], v[68:71], v[188:191], v[224:239]
  ds_read_b64_tr_b16 v[204:205], v5 offset:18432
  ds_read_b64_tr_b16 v[206:207], v5 offset:19456
  s_waitcnt vmcnt(0)
  s_barrier
  s_waitcnt lgkmcnt(6)
  v_mfma_f32_32x32x16_bf16 v[208:223], v[72:75], v[192:195], v[208:223]
  ds_read_b64_tr_b16 v[176:177], v4 offset:32768
  ds_read_b64_tr_b16 v[178:179], v4 offset:33792
  s_waitcnt lgkmcnt(6)
  v_mfma_f32_32x32x16_bf16 v[224:239], v[72:75], v[196:199], v[224:239]
  ds_read_b64_tr_b16 v[180:181], v5 offset:32768
  ds_read_b64_tr_b16 v[182:183], v5 offset:33792
  s_waitcnt lgkmcnt(6)
  v_mfma_f32_32x32x16_bf16 v[208:223], v[76:79], v[200:203], v[208:223]
  ds_read_b64_tr_b16 v[184:185], v4 offset:34816
  ds_read_b64_tr_b16 v[186:187], v4 offset:35840
  s_waitcnt lgkmcnt(6)
  v_mfma_f32_32x32x16_bf16 v[224:239], v[76:79], v[204:207], v[224:239]
  ds_read_b64_tr_b16 v[188:189], v5 offset:34816
  ds_read_b64_tr_b16 v[190:191], v5 offset:35840
  s_waitcnt lgkmcnt(6)
  v_mfma_f32_32x32x16_bf16 v[208:223], v[80:83], v[176:179], v[208:223]
  s_waitcnt lgkmcnt(4)
  v_mfma_f32_32x32x16_bf16 v[224:239], v[80:83], v[180:183], v[224:239]
  s_waitcnt lgkmcnt(2)
  v_mfma_f32_32x32x16_bf16 v[208:223], v[84:87], v[184:187], v[208:223]
  s_waitcnt lgkmcnt(0)
  v_mfma_f32_32x32x16_bf16 v[224:239], v[84:87], v[188:191], v[224:239]
  s_nop 15
  s_barrier
  s_lshl_b32 s76, s37, 11
  v_lshlrev_b32 v17, 4, v1
  v_add_u32 v18, s76, v17
  v_add_u32 v18, 32768, v18
  ds_write_b128 v18, v[208:211] offset:0
  ds_write_b128 v18, v[224:227] offset:1024
  ds_write_b128 v18, v[212:215] offset:8192
  ds_write_b128 v18, v[228:231] offset:9216
  ds_write_b128 v18, v[216:219] offset:16384
  ds_write_b128 v18, v[232:235] offset:17408
  ds_write_b128 v18, v[220:223] offset:24576
  ds_write_b128 v18, v[236:239] offset:25600
  s_lshl_b32 s76, s37, 13
  v_add_u32 v18, s76, v17
  v_add_u32 v18, 32768, v18
  s_waitcnt lgkmcnt(0)
  s_barrier
  ds_read_b128 v[128:131], v18 offset:0
  ds_read_b128 v[132:135], v18 offset:1024
  ds_read_b128 v[136:139], v18 offset:2048
  ds_read_b128 v[140:143], v18 offset:3072
  ds_read_b128 v[144:147], v18 offset:4096
  ds_read_b128 v[148:151], v18 offset:5120
  ds_read_b128 v[152:155], v18 offset:6144
  ds_read_b128 v[156:159], v18 offset:7168
  s_waitcnt lgkmcnt(0)
  v_add_f32 v128, v128, v136
  v_add_f32 v144, v144, v152
  v_add_f32 v129, v129, v137
  v_add_f32 v145, v145, v153
  v_add_f32 v130, v130, v138
  v_add_f32 v146, v146, v154
  v_add_f32 v131, v131, v139
  v_add_f32 v147, v147, v155
  v_add_f32 v132, v132, v140
  v_add_f32 v148, v148, v156
  v_add_f32 v133, v133, v141
  v_add_f32 v149, v149, v157
  v_add_f32 v134, v134, v142
  v_add_f32 v150, v150, v158
  v_add_f32 v135, v135, v143
  v_add_f32 v151, v151, v159
  v_add_f32 v128, v128, v144
  v_add_f32 v129, v129, v145
  v_add_f32 v130, v130, v146
  v_add_f32 v131, v131, v147
  v_add_f32 v132, v132, v148
  v_add_f32 v133, v133, v149
  v_add_f32 v134, v134, v150
  v_add_f32 v135, v135, v151
  v_add_f32 v128, v128, v120
  v_add_f32 v129, v129, v121
  v_add_f32 v130, v130, v122
  v_add_f32 v131, v131, v123
  v_add_f32 v132, v132, v124
  v_add_f32 v133, v133, v125
  v_add_f32 v134, v134, v126
  v_add_f32 v135, v135, v127
  s_mov_b32 s76, 0
  buffer_store_dword v128, v9, s[28:31], s76 offen offset:0 sc0 sc1
  s_mov_b32 s76, 0
  buffer_store_dword v129, v9, s[28:31], s76 offen offset:2048 sc0 sc1
  s_mov_b32 s76, 4096
  buffer_store_dword v130, v9, s[28:31], s76 offen offset:0 sc0 sc1
  s_mov_b32 s76, 4096
  buffer_store_dword v131, v9, s[28:31], s76 offen offset:2048 sc0 sc1
  s_mov_b32 s76, 0
  buffer_store_dword v132, v9, s[28:31], s76 offen offset:128 sc0 sc1
  s_mov_b32 s76, 0
  buffer_store_dword v133, v9, s[28:31], s76 offen offset:2176 sc0 sc1
  s_mov_b32 s76, 4096
  buffer_store_dword v134, v9, s[28:31], s76 offen offset:128 sc0 sc1
  s_mov_b32 s76, 4096
  buffer_store_dword v135, v9, s[28:31], s76 offen offset:2176 sc0 sc1
  s_endpgm
L_END:
  s_endpgm
L_CODE_END:
.section .rodata,"a"
.p2align 6
.amdhsa_kernel parallel_sum__ssm_conv_s5__glu_gated_geglu__prompt_kernel
  .amdhsa_next_free_vgpr 256
  .amdhsa_next_free_sgpr 102
  .amdhsa_accum_offset 256
  .amdhsa_group_segment_fixed_size 0
  .amdhsa_kernarg_size 128
  .amdhsa_user_sgpr_count 2
  .amdhsa_user_sgpr_kernarg_segment_ptr 1
  .amdhsa_system_sgpr_workgroup_id_x 1
.end_amdhsa_kernel
```
